```python
import torch

def _softmax(x, axis=-1):
    return torch.softmax(x, dim=axis)
def _gelu(x):
    return torch.nn.functional.gelu(x, approximate="tanh")
def _silu(x):
    return torch.nn.functional.silu(x)
def _sigmoid(x):
    return torch.sigmoid(x)
def _layernorm(x, axis=-1, eps=1e-5):
    m = x.mean(dim=axis, keepdim=True)
    v = x.var(dim=axis, keepdim=True, unbiased=False)
    return (x - m) / torch.sqrt(v + eps)
def _scatter_add(tgt, idx, src, axis=0):
    return tgt.clone().index_add_(axis, idx, src)
def _segment_sum(src, seg, n):
    out = torch.zeros((n,) + src.shape[1:], dtype=src.dtype)
    return out.index_add_(0, seg, src)
def _pad(x, pw):
    flat = tuple(v for pair in reversed(pw) for v in pair)
    return torch.nn.functional.pad(x, flat)

kernel_name = 'recurrent_scan__compressed_kv_cla__dense_activation_silu__decode'

def setup_inputs():

    _w = (lambda a: (lambda t: t.to(torch.bfloat16) if t.is_floating_point() else t)(torch.as_tensor(a)))
    def _A_setup():
        B, H, Sq, Sk, D, M = 1, 32, 1, 32768, 128, 512
        Dc = 4 * D
        return {
            "x": _w((lambda *s: torch.randn(*s, dtype=torch.bfloat16) * 0.1)(B, Sq, M)),
            "c_kv": _w((lambda *s: torch.randn(*s, dtype=torch.bfloat16) * 3.2)(B, Sk, Dc)),
            "w_q": _w((lambda *s: torch.randn(*s, dtype=torch.bfloat16) * 0.8)(M, H, D) * (M ** -0.5)),
            "w_uk": _w((lambda *s: torch.randn(*s, dtype=torch.bfloat16) * 0.8)(Dc, H, D) * (Dc ** -0.5)),
            "w_uv": _w((lambda *s: torch.randn(*s, dtype=torch.bfloat16) * 3.2)(Dc, H, D) * (Dc ** -0.5)),
            "w_o": _w((lambda *s: torch.randn(*s, dtype=torch.bfloat16) * 3.2)(H, D, M) * ((H * D) ** -0.5)),
        }
    _A_in = _A_setup()

    def _B_setup():
        B, S, D, F = 1, 1, 512, 1376
        return {
            "x": _w((lambda *s: torch.randn(*s, dtype=torch.bfloat16) * 0.1)(B, S, D)),
            "w1": _w((lambda *s: torch.randn(*s, dtype=torch.bfloat16) * 3.2)(D, F) * (D ** -0.5)),
            "w2": _w((lambda *s: torch.randn(*s, dtype=torch.bfloat16) * 0.8)(F, D) * (F ** -0.5)),
        }
    _B_in = _B_setup()

    return {
        "A_x": _A_in["x"],
        "A_c_kv": _A_in["c_kv"],
        "A_w_q": _A_in["w_q"],
        "A_w_uk": _A_in["w_uk"],
        "A_w_uv": _A_in["w_uv"],
        "A_w_o": _A_in["w_o"],
        "B_x": _B_in["x"],
        "B_w1": _B_in["w1"],
        "B_w2": _B_in["w2"],
    }

def reference(A_x, A_c_kv, A_w_q, A_w_uk, A_w_uv, A_w_o, B_x, B_w1, B_w2):
    def _A_ref(x, c_kv, w_q, w_uk, w_uv, w_o):
        B, Sq, M = x.shape[0], x.shape[1], x.shape[2]
        Sk = c_kv.shape[1]
        H, D = w_q.shape[1], w_q.shape[2]
        q = torch.einsum("bqm,mhd->bhqd", x, w_q)
        k = torch.einsum("bkc,chd->bhkd", c_kv, w_uk)
        v = torch.einsum("bkc,chd->bhkd", c_kv, w_uv)
        scores = torch.einsum("bhqd,bhkd->bhqk", q, k) * (D ** -0.5)
        off = Sk - Sq
        qi = torch.arange(Sq)[:, None]
        kj = torch.arange(Sk)[None, :]
        cmask = kj <= (qi + off)
        scores = torch.where(cmask[None, None], scores, -1e9)
        p = _softmax(scores, axis=-1)
        ctx = torch.einsum("bhqk,bhkd->bhqd", p, v)
        return torch.einsum("bhqd,hdm->bqm", ctx, w_o)

    def _B_ref(x, w1, w2):
        h = torch.einsum("bsd,df->bsf", x, w1)
        h = _silu(h)
        out = torch.einsum("bsf,fd->bsd", h, w2)
        return out

    x = A_x
    xn = _layernorm(x, axis=-1)
    s = _A_ref(xn, A_c_kv, A_w_q, A_w_uk, A_w_uv, A_w_o)
    g = _silu(_B_ref(xn, B_w1, B_w2))
    return x + s * g
```

```asm
; @launch grid=(256,1,1) block=(512,1,1) lds=163840
.amdgcn_target "amdgcn-amd-amdhsa--gfx950"
.text
.globl recurrent_scan__compressed_kv_cla__dense_activation_silu__decode_kernel
.p2align 8
.type recurrent_scan__compressed_kv_cla__dense_activation_silu__decode_kernel,@function
recurrent_scan__compressed_kv_cla__dense_activation_silu__decode_kernel:
L_start:
    s_cmp_ge_u32 s2, 256
    s_cbranch_scc1 L_end
    s_load_dwordx16 s[4:19], s[0:1], 0
    s_load_dwordx8 s[20:27], s[0:1], 64
    v_lshrrev_b32 v4, 6, v0
    v_and_b32 v1, 63, v0
    v_readfirstlane_b32 s28, v4
    v_lshlrev_b32 v3, 4, v1
    s_lshr_b32 s35, s2, 3
    v_mov_b32 v2, 147456
    s_sub_u32 s53, s28, 1
    s_cmp_ge_u32 s53, 2
    s_cbranch_scc1 pf_1
    s_cmp_lt_u32 s35, 16
    s_cbranch_scc1 pf_1
    s_getpc_b64 s[60:61]
L_pc:
    s_sub_u32 s60, s60, L_pc-L_start
    s_subb_u32 s61, s61, 0
    s_lshl_b32 s53, s53, 4
    s_add_u32 s53, s53, s35
    s_sub_u32 s53, s53, 16
    s_min_u32 s53, s53, (L_codeend-L_start)/1024
    s_lshl_b32 s53, s53, 10
    v_add_u32 v4, s53, v3
    global_load_dwordx4 v[56:59], v4, s[60:61]
pf_1:
    s_cmp_lg_u32 s28, 3
    s_cbranch_scc1 fi_2
    v_mov_b32 v6, 0
    v_lshl_add_u32 v7, v1, 2, v2
    ds_write_b32 v7, v6
fi_2:
    s_and_b32 s34, s2, 7
    s_and_b32 s53, s35, 15
    s_lshl_b32 s54, s34, 4
    s_or_b32 s3, s53, s54
    s_lshr_b32 s29, s3, 2
    s_mov_b32 s96, 0x05040100
    s_mov_b32 s97, 0x07060302
    s_and_b32 s31, s28, 3
    s_mov_b32 s42, 0x400
    s_mov_b32 s43, 0x20000
    s_mov_b32 s46, 0x400000
    s_mov_b32 s47, 0x20000
    s_mov_b32 s50, 0x400000
    s_mov_b32 s51, 0x20000
    s_and_b32 s52, s35, 3
    s_lshl_b32 s52, s52, 3
    s_or_b32 s52, s52, s28
    s_lshl_b32 s55, s52, 5
    s_lshl_b32 s52, s52, 17
    s_lshl_b32 s53, s29, 8
    s_add_u32 s56, s52, s53
    s_add_u32 s57, s56, 8192
    s_add_u32 s58, s56, 16384
    s_add_u32 s59, s56, 24576
    v_lshrrev_b32 v6, 4, v1
    v_and_b32 v7, 1, v1
    v_lshlrev_b32 v7, 2, v7
    v_lshl_add_u32 v19, v6, 3, v7
    v_lshlrev_b32 v13, 15, v6
    v_and_b32 v7, 15, v1
    v_lshl_add_u32 v13, v7, 4, v13
    s_cmp_ge_u32 s35, 16
    s_waitcnt lgkmcnt(0)
    s_cbranch_scc1 L_S
    s_mov_b32 s40, s4
    s_mov_b32 s41, s5
    s_mov_b32 s44, s8
    s_mov_b32 s45, s9
    buffer_load_dwordx4 v[8:11], v3, s[40:43], 0 offen
    buffer_load_dword v12, v19, s[40:43], s55 offen
    buffer_load_dwordx4 v[64:67], v13, s[44:47], s56 offen
    buffer_load_dwordx4 v[68:71], v13, s[44:47], s57 offen
    buffer_load_dwordx4 v[72:75], v13, s[44:47], s58 offen
    buffer_load_dwordx4 v[76:79], v13, s[44:47], s59 offen
    s_mov_b32 s48, s10
    s_mov_b32 s49, s11
    s_mov_b32 s16, s29
    s_load_dwordx2 s[32:33], s[26:27], 0
    s_load_dwordx2 s[24:25], s[26:27], 8
    s_mov_b32 s62, 0x00010001
    s_mov_b32 s36, s26
    s_mov_b32 s37, s27
    s_mov_b32 s38, 0x10000000
    s_mov_b32 s39, 0x20000
    s_barrier
    buffer_load_dwordx4 v[80:83], v13, s[48:51], s56 offen
    buffer_load_dwordx4 v[84:87], v13, s[48:51], s57 offen
    buffer_load_dwordx4 v[88:91], v13, s[48:51], s58 offen
    buffer_load_dwordx4 v[92:95], v13, s[48:51], s59 offen
    v_lshlrev_b32 v14, 3, v1
    s_lshl_b32 s53, s28, 9
    v_add_u32 v15, s53, v14
    v_lshlrev_b32 v16, 4, v7
    v_lshl_add_u32 v17, v6, 2, v16
    v_lshrrev_b32 v18, 2, v1
    v_lshlrev_b32 v18, 1, v18
    s_lshl_b32 s53, s28, 5
    v_add_u32 v18, s53, v18
    s_lshl_b32 s52, s3, 10
    s_add_u32 s52, s52, 65536
    s_lshl_b32 s53, s29, 12
    s_add_u32 s53, s53, 65536
    s_lshl_b32 s58, s3, 8
    s_add_u32 s58, s58, 589824
    v_mov_b32 v32, 0
    v_mov_b32 v33, 0
    v_mov_b32 v34, 0
    v_mov_b32 v35, 0
    v_mov_b32 v36, 0
    v_mov_b32 v37, 0
    v_mov_b32 v38, 0
    v_mov_b32 v39, 0
    s_waitcnt vmcnt(8)
    v_lshlrev_b32 v24, 16, v8
    v_and_b32 v25, 0xffff0000, v8
    v_lshlrev_b32 v26, 16, v9
    v_and_b32 v27, 0xffff0000, v9
    v_lshlrev_b32 v28, 16, v10
    v_and_b32 v29, 0xffff0000, v10
    v_lshlrev_b32 v30, 16, v11
    v_and_b32 v31, 0xffff0000, v11
    v_add_f32 v20, v24, v25
    v_add_f32 v20, v20, v26
    v_add_f32 v20, v20, v27
    v_add_f32 v20, v20, v28
    v_add_f32 v20, v20, v29
    v_add_f32 v20, v20, v30
    v_add_f32 v20, v20, v31
    s_nop 1
    v_add_f32_dpp v20, v20, v20 quad_perm:[1,0,3,2] row_mask:0xf bank_mask:0xf
    s_nop 1
    v_add_f32_dpp v20, v20, v20 quad_perm:[2,3,0,1] row_mask:0xf bank_mask:0xf
    s_nop 1
    v_add_f32_dpp v20, v20, v20 row_half_mirror row_mask:0xf bank_mask:0xf
    s_nop 1
    v_add_f32_dpp v20, v20, v20 row_mirror row_mask:0xf bank_mask:0xf
    v_mov_b32 v22, v20
    s_nop 1
    v_permlane16_swap_b32 v22, v20
    v_add_f32 v20, v20, v22
    v_mov_b32 v22, v20
    s_nop 1
    v_permlane32_swap_b32 v22, v20
    v_add_f32 v20, v20, v22
    v_mul_f32 v20, 0x3b000000, v20
    v_sub_f32 v24, v24, v20
    v_sub_f32 v25, v25, v20
    v_sub_f32 v26, v26, v20
    v_sub_f32 v27, v27, v20
    v_sub_f32 v28, v28, v20
    v_sub_f32 v29, v29, v20
    v_sub_f32 v30, v30, v20
    v_sub_f32 v31, v31, v20
    v_mul_f32 v21, v24, v24
    v_fmac_f32 v21, v25, v25
    v_fmac_f32 v21, v26, v26
    v_fmac_f32 v21, v27, v27
    v_fmac_f32 v21, v28, v28
    v_fmac_f32 v21, v29, v29
    v_fmac_f32 v21, v30, v30
    v_fmac_f32 v21, v31, v31
    s_nop 1
    v_add_f32_dpp v21, v21, v21 quad_perm:[1,0,3,2] row_mask:0xf bank_mask:0xf
    s_nop 1
    v_add_f32_dpp v21, v21, v21 quad_perm:[2,3,0,1] row_mask:0xf bank_mask:0xf
    s_nop 1
    v_add_f32_dpp v21, v21, v21 row_half_mirror row_mask:0xf bank_mask:0xf
    s_nop 1
    v_add_f32_dpp v21, v21, v21 row_mirror row_mask:0xf bank_mask:0xf
    v_mov_b32 v22, v21
    s_nop 1
    v_permlane16_swap_b32 v22, v21
    v_add_f32 v21, v21, v22
    v_mov_b32 v22, v21
    s_nop 1
    v_permlane32_swap_b32 v22, v21
    v_add_f32 v21, v21, v22
    v_mul_f32 v21, 0x3b000000, v21
    v_cvt_pk_bf16_f32 v20, v20, v20
    v_and_b32 v20, 0xffff0000, v20
    v_cvt_pk_bf16_f32 v21, v21, v21
    v_and_b32 v21, 0xffff0000, v21
    v_add_f32 v21, 0x3727c5ac, v21
    v_cvt_pk_bf16_f32 v21, v21, v21
    v_and_b32 v21, 0xffff0000, v21
    v_sqrt_f32 v21, v21
    s_nop 0
    v_cvt_pk_bf16_f32 v21, v21, v21
    v_and_b32 v21, 0xffff0000, v21
    v_rcp_f32 v21, v21
    v_lshlrev_b32 v22, 16, v12
    v_and_b32 v23, 0xffff0000, v12
    v_sub_f32 v22, v22, v20
    v_sub_f32 v23, v23, v20
    v_cvt_pk_bf16_f32 v12, v22, v23
    v_lshlrev_b32 v22, 16, v12
    v_and_b32 v23, 0xffff0000, v12
    v_mul_f32 v22, v22, v21
    v_mul_f32 v23, v23, v21
    v_cvt_pk_bf16_f32 v12, v22, v23
    s_waitcnt vmcnt(6)
    v_perm_b32 v48, v68, v64, s96
    v_perm_b32 v49, v68, v64, s97
    v_perm_b32 v50, v69, v65, s96
    v_perm_b32 v51, v69, v65, s97
    v_perm_b32 v52, v70, v66, s96
    v_perm_b32 v53, v70, v66, s97
    v_perm_b32 v54, v71, v67, s96
    v_perm_b32 v55, v71, v67, s97
    v_dot2c_f32_bf16_dpp v32, v12, v48 row_newbcast:0 row_mask:0xf bank_mask:0xf
    v_dot2c_f32_bf16_dpp v33, v12, v49 row_newbcast:0 row_mask:0xf bank_mask:0xf
    v_dot2c_f32_bf16_dpp v34, v12, v50 row_newbcast:0 row_mask:0xf bank_mask:0xf
    v_dot2c_f32_bf16_dpp v35, v12, v51 row_newbcast:0 row_mask:0xf bank_mask:0xf
    v_dot2c_f32_bf16_dpp v36, v12, v52 row_newbcast:0 row_mask:0xf bank_mask:0xf
    v_dot2c_f32_bf16_dpp v37, v12, v53 row_newbcast:0 row_mask:0xf bank_mask:0xf
    v_dot2c_f32_bf16_dpp v38, v12, v54 row_newbcast:0 row_mask:0xf bank_mask:0xf
    v_dot2c_f32_bf16_dpp v39, v12, v55 row_newbcast:0 row_mask:0xf bank_mask:0xf
    s_waitcnt vmcnt(4)
    v_perm_b32 v48, v76, v72, s96
    v_perm_b32 v49, v76, v72, s97
    v_perm_b32 v50, v77, v73, s96
    v_perm_b32 v51, v77, v73, s97
    v_perm_b32 v52, v78, v74, s96
    v_perm_b32 v53, v78, v74, s97
    v_perm_b32 v54, v79, v75, s96
    v_perm_b32 v55, v79, v75, s97
    v_dot2c_f32_bf16_dpp v32, v12, v48 row_newbcast:1 row_mask:0xf bank_mask:0xf
    v_dot2c_f32_bf16_dpp v33, v12, v49 row_newbcast:1 row_mask:0xf bank_mask:0xf
    v_dot2c_f32_bf16_dpp v34, v12, v50 row_newbcast:1 row_mask:0xf bank_mask:0xf
    v_dot2c_f32_bf16_dpp v35, v12, v51 row_newbcast:1 row_mask:0xf bank_mask:0xf
    v_dot2c_f32_bf16_dpp v36, v12, v52 row_newbcast:1 row_mask:0xf bank_mask:0xf
    v_dot2c_f32_bf16_dpp v37, v12, v53 row_newbcast:1 row_mask:0xf bank_mask:0xf
    v_dot2c_f32_bf16_dpp v38, v12, v54 row_newbcast:1 row_mask:0xf bank_mask:0xf
    v_dot2c_f32_bf16_dpp v39, v12, v55 row_newbcast:1 row_mask:0xf bank_mask:0xf
    v_permlane32_swap_b32 v32, v36
    v_permlane32_swap_b32 v33, v37
    v_permlane32_swap_b32 v34, v38
    v_permlane32_swap_b32 v35, v39
    v_add_f32 v32, v32, v36
    v_add_f32 v33, v33, v37
    v_add_f32 v34, v34, v38
    v_add_f32 v35, v35, v39
    s_nop 0
    v_permlane16_swap_b32 v32, v34
    v_permlane16_swap_b32 v33, v35
    v_add_f32 v32, v32, v34
    v_add_f32 v33, v33, v35
    ds_write_b64 v15, v[32:33]
    s_waitcnt lgkmcnt(0)
    s_mul_i32 s32, s32, 0x9E3779B1
    s_add_u32 s32, s32, 0x7F4A7C15
    s_mul_i32 s33, s33, 0x85EBCA6D
    s_add_u32 s33, s33, 0x2545F491
    s_xor_b32 s24, s24, 0x395b586c
    s_xor_b32 s25, s25, 0xc3e4962d
    s_barrier
    s_cmp_lg_u32 s28, 0
    s_cbranch_scc1 p1_3
    ds_read_b64 v[48:49], v14 offset:0
    ds_read_b64 v[50:51], v14 offset:512
    ds_read_b64 v[52:53], v14 offset:1024
    ds_read_b64 v[54:55], v14 offset:1536
    ds_read_b64 v[56:57], v14 offset:2048
    ds_read_b64 v[58:59], v14 offset:2560
    ds_read_b64 v[60:61], v14 offset:3072
    ds_read_b64 v[62:63], v14 offset:3584
    v_mov_b32 v34, s32
    v_mov_b32 v35, s33
    s_waitcnt lgkmcnt(0)
    v_add_f32 v48, v48, v56
    v_add_f32 v49, v49, v57
    v_add_f32 v50, v50, v58
    v_add_f32 v51, v51, v59
    v_add_f32 v52, v52, v60
    v_add_f32 v53, v53, v61
    v_add_f32 v54, v54, v62
    v_add_f32 v55, v55, v63
    v_add_f32 v48, v48, v52
    v_add_f32 v49, v49, v53
    v_add_f32 v50, v50, v54
    v_add_f32 v51, v51, v55
    v_add_f32 v32, v48, v50
    v_add_f32 v33, v49, v51
    buffer_store_dwordx4 v[32:35], v3, s[36:39], s52 offen
    s_add_u32 s52, s52, 262144
    buffer_store_dwordx4 v[32:35], v3, s[36:39], s52 offen sc1
    s_branch pb_4
p1_3:
    s_cmp_lg_u32 s28, 1
    s_cbranch_scc1 pb_4
    s_mov_b32 s98, 0
qp_5:
    buffer_load_dwordx4 v[48:51], v3, s[36:39], s53 offen offset:0 sc1
    buffer_load_dwordx4 v[52:55], v3, s[36:39], s53 offen offset:1024 sc1
    buffer_load_dwordx4 v[56:59], v3, s[36:39], s53 offen offset:2048 sc1
    buffer_load_dwordx4 v[60:63], v3, s[36:39], s53 offen offset:3072 sc1
    s_waitcnt vmcnt(0)
    v_cmp_eq_u64 s[56:57], s[32:33], v[50:51]
    v_cmp_eq_u64 vcc, s[32:33], v[54:55]
    s_nop 0
    s_and_b64 s[56:57], s[56:57], vcc
    v_cmp_eq_u64 vcc, s[32:33], v[58:59]
    s_nop 0
    s_and_b64 s[56:57], s[56:57], vcc
    v_cmp_eq_u64 vcc, s[32:33], v[62:63]
    s_nop 0
    s_and_b64 s[56:57], s[56:57], vcc
    s_cmp_eq_u64 s[56:57], -1
    s_cbranch_scc1 qpd_6
    s_add_u32 s98, s98, 1
    s_cmp_lg_u32 s98, 24
    s_cbranch_scc1 qpn_7
    s_add_u32 s53, s53, 262144
qpn_7:
    s_cmp_lt_u32 s98, 200000
    s_cbranch_scc1 qp_5
qpd_6:
    v_add_f32 v48, v48, v52
    v_add_f32 v49, v49, v53
    v_add_f32 v56, v56, v60
    v_add_f32 v57, v57, v61
    v_add_f32 v48, v48, v56
    v_add_f32 v49, v49, v57
    v_cvt_pk_bf16_f32 v48, v48, v49
    ds_write_b32 v17, v48 offset:4096
pb_4:
    v_and_b32 v13, 7, v1
    v_lshlrev_b32 v14, 3, v13
    v_lshrrev_b64 v[14:15], v14, s[24:25]
    v_and_b32 v14, 0xff, v14
    v_lshl_or_b32 v14, v14, 15, v14
    v_lshrrev_b32 v240, 0, v14
    v_and_b32 v240, s62, v240
    v_lshrrev_b32 v241, 2, v14
    v_and_b32 v241, s62, v241
    v_lshrrev_b32 v242, 4, v14
    v_and_b32 v242, s62, v242
    v_lshrrev_b32 v243, 6, v14
    v_and_b32 v243, s62, v243
    s_mov_b32 s57, 0xffff
    s_mov_b32 s54, 0xffff
    s_mov_b32 s55, 0xffff
    s_waitcnt lgkmcnt(0)
    s_barrier
    ds_read_b128 v[48:51], v16 offset:4096
    s_waitcnt vmcnt(2) lgkmcnt(0)
    s_cmp_eq_u32 s28, 0
    s_cbranch_scc1 w0_8
    s_waitcnt vmcnt(0)
w0_8:
    v_dot2_f32_bf16 v36, v80, v48, 0
    v_dot2_f32_bf16 v37, v84, v48, 0
    v_dot2_f32_bf16 v38, v88, v48, 0
    v_dot2_f32_bf16 v39, v92, v48, 0
    v_dot2_f32_bf16 v36, v81, v49, v36
    v_dot2_f32_bf16 v37, v85, v49, v37
    v_dot2_f32_bf16 v38, v89, v49, v38
    v_dot2_f32_bf16 v39, v93, v49, v39
    v_dot2_f32_bf16 v36, v82, v50, v36
    v_dot2_f32_bf16 v37, v86, v50, v37
    v_dot2_f32_bf16 v38, v90, v50, v38
    v_dot2_f32_bf16 v39, v94, v50, v39
    v_dot2_f32_bf16 v36, v83, v51, v36
    v_dot2_f32_bf16 v37, v87, v51, v37
    v_dot2_f32_bf16 v38, v91, v51, v38
    v_dot2_f32_bf16 v39, v95, v51, v39
    v_add_f32_dpp v52, v36, v36 row_ror:8 row_mask:0xf bank_mask:0x3
    v_add_f32_dpp v53, v37, v37 row_ror:8 row_mask:0xf bank_mask:0x3
    s_nop 0
    v_add_f32_dpp v52, v38, v38 row_ror:8 row_mask:0xf bank_mask:0xc
    v_add_f32_dpp v53, v39, v39 row_ror:8 row_mask:0xf bank_mask:0xc
    s_nop 0
    v_add_f32_dpp v54, v52, v52 row_half_mirror row_mask:0xf bank_mask:0x5
    s_nop 1
    v_add_f32_dpp v54, v53, v53 row_half_mirror row_mask:0xf bank_mask:0xa
    s_nop 1
    v_add_f32_dpp v54, v54, v54 quad_perm:[1,0,3,2] row_mask:0xf bank_mask:0xf
    s_nop 1
    v_add_f32_dpp v54, v54, v54 quad_perm:[2,3,0,1] row_mask:0xf bank_mask:0xf
    v_mul_f32 v54, 0x3e0293ee, v54
    v_bfe_u32 v53, v54, 17, 1
    v_add3_u32 v53, v54, v53, s57
    v_cvt_pk_bf16_f32 v54, v54, v54
    v_lshrrev_b32 v53, 16, v53
    v_cndmask_b32 v54, v54, v53, s[54:55]
    ds_write_b16 v18, v54 offset:4608
    s_waitcnt lgkmcnt(0)
    s_barrier
    s_cmp_lg_u32 s28, 2
    s_cbranch_scc1 L_px
    ds_read_b128 v[48:51], v16 offset:4608
    s_mov_b64 exec, 0xffff
    s_waitcnt lgkmcnt(0)
    v_bfi_b32 v48, s62, v240, v48
    v_bfi_b32 v49, s62, v241, v49
    buffer_store_dwordx4 v[48:51], v3, s[36:39], s58 offen sc1
    v_lshlrev_b32 v8, 6, v1
    v_mov_b32 v9, s32
    s_lshl_b32 s52, s34, 10
    s_lshl_b32 s53, s35, 2
    s_add_u32 s52, s52, s53
    s_add_u32 s52, s52, 917504
    buffer_store_dword v9, v8, s[36:39], s52 offen
    s_mov_b64 exec, -1
L_px:
    s_sub_u32 s52, s35, 0
    s_cmp_ge_u32 s52, 6
    s_cbranch_scc1 nf_9
    s_mul_i32 s100, s34, 6
    s_add_u32 s100, s100, s52
    s_barrier
    s_mov_b32 s44, s18
    s_mov_b32 s45, s19
    s_mov_b32 s46, 0x158000
    s_mov_b32 s47, 0x20000
    s_mov_b32 s48, s20
    s_mov_b32 s49, s21
    s_mov_b32 s50, 0x158000
    s_mov_b32 s51, 0x20000
    v_lshrrev_b32 v4, 2, v1
    v_and_b32 v6, 3, v1
    v_and_b32 v5, 7, v1
    v_lshlrev_b32 v8, 3, v4
    s_lshl_b32 s52, s28, 7
    buffer_load_dwordx2 v[24:25], v8, s[40:43], s52 offen
    v_mul_u32_u24 v8, 11008, v4
    v_lshl_add_u32 v8, v6, 4, v8
    s_mul_i32 s52, s28, 176128
    s_lshl_b32 s53, s100, 6
    s_add_u32 s52, s52, s53
    buffer_load_dwordx4 v[96:99], v8, s[44:47], s52 offen
    s_add_u32 s52, s52, 2752
    buffer_load_dwordx4 v[100:103], v8, s[44:47], s52 offen
    s_add_u32 s52, s52, 2752
    buffer_load_dwordx4 v[104:107], v8, s[44:47], s52 offen
    s_add_u32 s52, s52, 2752
    buffer_load_dwordx4 v[108:111], v8, s[44:47], s52 offen
    s_add_u32 s52, s52, 2752
    s_lshl_b32 s52, s100, 3
    s_add_u32 s52, s52, s28
    s_lshl_b32 s52, s52, 12
    buffer_load_dwordx4 v[136:139], v3, s[48:51], s52 offen offset:0
    buffer_load_dwordx4 v[140:143], v3, s[48:51], s52 offen offset:1024
    buffer_load_dwordx4 v[144:147], v3, s[48:51], s52 offen offset:2048
    buffer_load_dwordx4 v[148:151], v3, s[48:51], s52 offen offset:3072
    s_waitcnt vmcnt(8)
    v_lshlrev_b32 v22, 16, v24
    v_and_b32 v23, 0xffff0000, v24
    v_sub_f32 v22, v22, v20
    v_sub_f32 v23, v23, v20
    v_cvt_pk_bf16_f32 v24, v22, v23
    v_lshlrev_b32 v22, 16, v24
    v_and_b32 v23, 0xffff0000, v24
    v_mul_f32 v22, v22, v21
    v_mul_f32 v23, v23, v21
    v_cvt_pk_bf16_f32 v24, v22, v23
    v_lshlrev_b32 v22, 16, v25
    v_and_b32 v23, 0xffff0000, v25
    v_sub_f32 v22, v22, v20
    v_sub_f32 v23, v23, v20
    v_cvt_pk_bf16_f32 v25, v22, v23
    v_lshlrev_b32 v22, 16, v25
    v_and_b32 v23, 0xffff0000, v25
    v_mul_f32 v22, v22, v21
    v_mul_f32 v23, v23, v21
    v_cvt_pk_bf16_f32 v25, v22, v23
    s_waitcnt vmcnt(6)
    v_perm_b32 v48, v100, v96, s96
    v_perm_b32 v49, v100, v96, s97
    v_perm_b32 v50, v101, v97, s96
    v_perm_b32 v51, v101, v97, s97
    v_perm_b32 v52, v102, v98, s96
    v_perm_b32 v53, v102, v98, s97
    v_perm_b32 v54, v103, v99, s96
    v_perm_b32 v55, v103, v99, s97
    v_dot2_f32_bf16 v32, v48, v24, 0
    v_dot2_f32_bf16 v33, v49, v24, 0
    v_dot2_f32_bf16 v34, v50, v24, 0
    v_dot2_f32_bf16 v35, v51, v24, 0
    v_dot2_f32_bf16 v36, v52, v24, 0
    v_dot2_f32_bf16 v37, v53, v24, 0
    v_dot2_f32_bf16 v38, v54, v24, 0
    v_dot2_f32_bf16 v39, v55, v24, 0
    s_waitcnt vmcnt(4)
    v_perm_b32 v48, v108, v104, s96
    v_perm_b32 v49, v108, v104, s97
    v_perm_b32 v50, v109, v105, s96
    v_perm_b32 v51, v109, v105, s97
    v_perm_b32 v52, v110, v106, s96
    v_perm_b32 v53, v110, v106, s97
    v_perm_b32 v54, v111, v107, s96
    v_perm_b32 v55, v111, v107, s97
    v_dot2c_f32_bf16 v32, v48, v25
    v_dot2c_f32_bf16 v33, v49, v25
    v_dot2c_f32_bf16 v34, v50, v25
    v_dot2c_f32_bf16 v35, v51, v25
    v_dot2c_f32_bf16 v36, v52, v25
    v_dot2c_f32_bf16 v37, v53, v25
    v_dot2c_f32_bf16 v38, v54, v25
    v_dot2c_f32_bf16 v39, v55, v25
    v_permlane32_swap_b32 v32, v36
    v_permlane32_swap_b32 v33, v37
    v_permlane32_swap_b32 v34, v38
    v_permlane32_swap_b32 v35, v39
    v_add_f32 v32, v32, v36
    v_add_f32 v33, v33, v37
    v_add_f32 v34, v34, v38
    v_add_f32 v35, v35, v39
    s_nop 0
    v_permlane16_swap_b32 v32, v34
    v_permlane16_swap_b32 v33, v35
    v_add_f32 v32, v32, v34
    v_add_f32 v33, v33, v35
    s_nop 0
    v_add_f32_dpp v32, v32, v32 row_ror:8 row_mask:0xf bank_mask:0xf
    v_add_f32_dpp v33, v33, v33 row_ror:8 row_mask:0xf bank_mask:0xf
    s_nop 0
    v_add_f32_dpp v32, v32, v32 row_ror:4 row_mask:0xf bank_mask:0xf
    v_add_f32_dpp v33, v33, v33 row_ror:4 row_mask:0xf bank_mask:0xf
    v_lshrrev_b32 v9, 4, v1
    v_lshlrev_b32 v10, 3, v9
    v_lshl_add_u32 v10, v6, 5, v10
    s_lshl_b32 s52, s28, 7
    v_add_u32 v10, s52, v10
    ds_write_b64 v10, v[32:33] offset:8192
    v_lshlrev_b32 v10, 7, v5
    v_and_b32 v11, 8, v1
    v_add_u32 v10, v10, v11
    s_lshl_b32 s52, s28, 4
    v_add_u32 v10, s52, v10
    s_waitcnt lgkmcnt(0)
    s_barrier
    ds_read_b64 v[32:33], v10 offset:8192
    s_waitcnt vmcnt(0)
    v_perm_b32 v128, v140, v136, s96
    v_perm_b32 v129, v140, v136, s97
    v_perm_b32 v130, v141, v137, s96
    v_perm_b32 v131, v141, v137, s97
    v_perm_b32 v132, v142, v138, s96
    v_perm_b32 v133, v142, v138, s97
    v_perm_b32 v134, v143, v139, s96
    v_perm_b32 v135, v143, v139, s97
    v_perm_b32 v136, v148, v144, s96
    v_perm_b32 v137, v148, v144, s97
    v_perm_b32 v138, v149, v145, s96
    v_perm_b32 v139, v149, v145, s97
    v_perm_b32 v140, v150, v146, s96
    v_perm_b32 v141, v150, v146, s97
    v_perm_b32 v142, v151, v147, s96
    v_perm_b32 v143, v151, v147, s97
    s_waitcnt lgkmcnt(0)
    v_add_f32_dpp v32, v32, v32 quad_perm:[1,0,3,2] row_mask:0xf bank_mask:0xf
    v_add_f32_dpp v33, v33, v33 quad_perm:[1,0,3,2] row_mask:0xf bank_mask:0xf
    s_nop 0
    v_add_f32_dpp v32, v32, v32 quad_perm:[2,3,0,1] row_mask:0xf bank_mask:0xf
    v_add_f32_dpp v33, v33, v33 quad_perm:[2,3,0,1] row_mask:0xf bank_mask:0xf
    s_nop 0
    v_add_f32_dpp v32, v32, v32 row_half_mirror row_mask:0xf bank_mask:0xf
    v_add_f32_dpp v33, v33, v33 row_half_mirror row_mask:0xf bank_mask:0xf
    v_cvt_pk_bf16_f32 v32, v32, v32
    v_and_b32 v32, 0xffff0000, v32
    v_mul_f32 v34, 0xbfb8aa3b, v32
    v_exp_f32 v34, v34
    s_nop 0
    v_add_f32 v34, 1.0, v34
    v_rcp_f32 v34, v34
    s_nop 0
    v_mul_f32 v32, v32, v34
    v_cvt_pk_bf16_f32 v33, v33, v33
    v_and_b32 v33, 0xffff0000, v33
    v_mul_f32 v34, 0xbfb8aa3b, v33
    v_exp_f32 v34, v34
    s_nop 0
    v_add_f32 v34, 1.0, v34
    v_rcp_f32 v34, v34
    s_nop 0
    v_mul_f32 v33, v33, v34
    v_cvt_pk_bf16_f32 v32, v32, v33
    s_nop 0
    v_readlane_b32 s54, v32, 0
    v_readlane_b32 s55, v32, 8
    s_nop 0
    v_dot2_f32_bf16 v40, v128, s54, 0
    v_dot2_f32_bf16 v41, v129, s54, 0
    v_dot2_f32_bf16 v42, v130, s54, 0
    v_dot2_f32_bf16 v43, v131, s54, 0
    v_dot2_f32_bf16 v44, v132, s54, 0
    v_dot2_f32_bf16 v45, v133, s54, 0
    v_dot2_f32_bf16 v46, v134, s54, 0
    v_dot2_f32_bf16 v47, v135, s54, 0
    v_dot2_f32_bf16 v40, v136, s55, v40
    v_dot2_f32_bf16 v41, v137, s55, v41
    v_dot2_f32_bf16 v42, v138, s55, v42
    v_dot2_f32_bf16 v43, v139, s55, v43
    v_dot2_f32_bf16 v44, v140, s55, v44
    v_dot2_f32_bf16 v45, v141, s55, v45
    v_dot2_f32_bf16 v46, v142, s55, v46
    v_dot2_f32_bf16 v47, v143, s55, v47
    v_lshlrev_b32 v10, 5, v1
    s_lshl_b32 s52, s28, 11
    v_add_u32 v10, s52, v10
    ds_write_b128 v10, v[40:43] offset:16384
    ds_write_b128 v10, v[44:47] offset:16400
    v_lshlrev_b32 v10, 5, v5
    v_lshl_add_u32 v10, v9, 3, v10
    v_and_b32 v11, 8, v1
    v_lshl_add_u32 v10, v11, 10, v10
    s_lshl_b32 s52, s28, 8
    v_add_u32 v10, s52, v10
    v_lshlrev_b32 v11, 16, v9
    v_lshl_add_u32 v11, v5, 4, v11
    s_lshl_b32 s52, s28, 13
    s_lshl_b32 s53, s100, 7
    s_add_u32 s52, s52, s53
    s_add_u32 s52, s52, 3145728
    s_waitcnt lgkmcnt(0)
    s_barrier
    ds_read_b64 v[32:33], v10 offset:16384
    ds_read_b64 v[34:35], v10 offset:18432
    ds_read_b64 v[36:37], v10 offset:20480
    ds_read_b64 v[38:39], v10 offset:22528
    s_waitcnt lgkmcnt(0)
    v_add_f32 v32, v32, v34
    v_add_f32 v33, v33, v35
    v_add_f32 v36, v36, v38
    v_add_f32 v37, v37, v39
    v_add_f32 v32, v32, v36
    v_add_f32 v33, v33, v37
    v_mov_b32 v34, s32
    v_mov_b32 v35, s33
    v_add_f32_dpp v32, v32, v32 row_ror:8 row_mask:0xf bank_mask:0xf
    v_add_f32_dpp v33, v33, v33 row_ror:8 row_mask:0xf bank_mask:0xf
    s_mov_b32 exec_lo, 0x00ff00ff
    s_mov_b32 exec_hi, 0x00ff00ff
    buffer_store_dwordx4 v[32:35], v11, s[36:39], s52 offen sc1
    s_mov_b64 exec, -1
nf_9:
    s_cmp_lg_u32 s28, 7
    s_cbranch_scc1 L_pwait
    s_lshl_b32 s52, s34, 13
    s_add_u32 s52, s52, 720896
    v_and_b32 v10, 15, v1
    v_lshlrev_b32 v10, 9, v10
    s_mov_b32 s98, 200000
    s_mov_b64 exec, 0xffff
hi_10:
    s_sleep 4
    buffer_load_dwordx2 v[8:9], v10, s[36:39], s52 offen sc1
    s_waitcnt vmcnt(0)
    v_cmp_eq_u64 vcc, s[32:33], v[8:9]
    s_nop 0
    s_bcnt1_i32_b64 s101, vcc
    s_cmp_ge_u32 s101, 8
    s_cbranch_scc1 hid_11
    s_sub_u32 s98, s98, 1
    s_cmp_lg_u32 s98, 0
    s_cbranch_scc1 hi_10
hid_11:
    s_mov_b64 exec, -1
    v_mov_b32 v8, 1
    ds_write_b32 v2, v8 offset:8
L_pwait:
    s_and_b32 s52, s35, 3
    s_lshl_b32 s30, s52, 1
    s_lshr_b32 s52, s28, 2
    s_or_b32 s30, s30, s52
    s_xor_b32 s17, s31, s52
    s_and_b32 s0, s28, 4
    v_lshrrev_b32 v4, 3, v1
    v_and_b32 v5, 7, v1
    s_mov_b32 s98, 3200000
wf_12:
    ds_read_b32 v8, v2 offset:8
    s_waitcnt lgkmcnt(0)
    v_readfirstlane_b32 s101, v8
    s_nop 0
    s_cmp_lg_u32 s101, 0
    s_cbranch_scc1 wfd_13
    s_sleep 1
    s_sub_u32 s98, s98, 1
    s_cmp_lg_u32 s98, 0
    s_cbranch_scc1 wf_12
wfd_13:
    s_mov_b32 s48, s14
    s_mov_b32 s49, s15
    s_mov_b32 s50, 0x400000
    s_mov_b32 s51, 0x20000
    v_lshlrev_b32 v6, 14, v4
    v_lshl_add_u32 v6, v5, 4, v6
    s_lshl_b32 s58, s16, 17
    s_lshl_b32 s59, s28, 7
    s_add_u32 s58, s58, s59
    s_cmp_lg_u32 s17, 0
    s_cbranch_scc1 nw_14
    s_mov_b32 s44, s12
    s_mov_b32 s45, s13
    s_mov_b32 s46, 0x400000
    s_mov_b32 s47, 0x20000
    v_bfe_u32 v8, v1, 4, 1
    v_lshlrev_b32 v8, 5, v8
    v_lshrrev_b32 v9, 5, v1
    v_lshl_add_u32 v8, v9, 2, v8
    v_lshlrev_b32 v8, 13, v8
    v_and_b32 v9, 15, v1
    v_lshl_add_u32 v8, v9, 4, v8
    s_lshl_b32 s54, s30, 19
    s_lshl_b32 s55, s16, 8
    s_add_u32 s54, s54, s55
    s_add_u32 s55, s54, 0
    buffer_load_dwordx4 v[72:75], v8, s[44:47], s55 offen
    s_add_u32 s55, s54, 8192
    buffer_load_dwordx4 v[76:79], v8, s[44:47], s55 offen
    s_add_u32 s55, s54, 16384
    buffer_load_dwordx4 v[80:83], v8, s[44:47], s55 offen
    s_add_u32 s55, s54, 24576
    buffer_load_dwordx4 v[84:87], v8, s[44:47], s55 offen
    s_add_u32 s55, s54, 65536
    buffer_load_dwordx4 v[88:91], v8, s[44:47], s55 offen
    s_add_u32 s55, s54, 73728
    buffer_load_dwordx4 v[92:95], v8, s[44:47], s55 offen
    s_add_u32 s55, s54, 81920
    buffer_load_dwordx4 v[96:99], v8, s[44:47], s55 offen
    s_add_u32 s55, s54, 90112
    buffer_load_dwordx4 v[100:103], v8, s[44:47], s55 offen
    s_add_u32 s55, s54, 131072
    buffer_load_dwordx4 v[104:107], v8, s[44:47], s55 offen
    s_add_u32 s55, s54, 139264
    buffer_load_dwordx4 v[108:111], v8, s[44:47], s55 offen
    s_add_u32 s55, s54, 147456
    buffer_load_dwordx4 v[112:115], v8, s[44:47], s55 offen
    s_add_u32 s55, s54, 155648
    buffer_load_dwordx4 v[116:119], v8, s[44:47], s55 offen
    s_add_u32 s55, s54, 196608
    buffer_load_dwordx4 v[120:123], v8, s[44:47], s55 offen
    s_add_u32 s55, s54, 204800
    buffer_load_dwordx4 v[124:127], v8, s[44:47], s55 offen
    s_add_u32 s55, s54, 212992
    buffer_load_dwordx4 v[128:131], v8, s[44:47], s55 offen
    s_add_u32 s55, s54, 221184
    buffer_load_dwordx4 v[132:135], v8, s[44:47], s55 offen
nw_14:
    s_and_b32 s59, s35, 3
    s_cmp_eq_u32 s59, 1
    s_cbranch_scc1 wq_17
    s_cmp_eq_u32 s59, 2
    s_cbranch_scc1 wq_18
    s_cmp_eq_u32 s59, 3
    s_cbranch_scc1 wq_19
wq_16:
    s_add_u32 s60, s58, 0
    buffer_load_dwordx4 v[136:139], v6, s[48:51], s60 offen offset:0
    buffer_load_dwordx4 v[140:143], v6, s[48:51], s60 offen offset:1024
    buffer_load_dwordx4 v[144:147], v6, s[48:51], s60 offen offset:2048
    buffer_load_dwordx4 v[148:151], v6, s[48:51], s60 offen offset:3072
wq_17:
    s_add_u32 s60, s58, 4096
    buffer_load_dwordx4 v[152:155], v6, s[48:51], s60 offen offset:0
    buffer_load_dwordx4 v[156:159], v6, s[48:51], s60 offen offset:1024
    buffer_load_dwordx4 v[160:163], v6, s[48:51], s60 offen offset:2048
    buffer_load_dwordx4 v[164:167], v6, s[48:51], s60 offen offset:3072
wq_18:
    s_add_u32 s60, s58, 8192
    buffer_load_dwordx4 v[168:171], v6, s[48:51], s60 offen offset:0
    buffer_load_dwordx4 v[172:175], v6, s[48:51], s60 offen offset:1024
    buffer_load_dwordx4 v[176:179], v6, s[48:51], s60 offen offset:2048
    buffer_load_dwordx4 v[180:183], v6, s[48:51], s60 offen offset:3072
wq_19:
    s_add_u32 s60, s58, 12288
    buffer_load_dwordx4 v[184:187], v6, s[48:51], s60 offen offset:0
    buffer_load_dwordx4 v[188:191], v6, s[48:51], s60 offen offset:1024
    buffer_load_dwordx4 v[192:195], v6, s[48:51], s60 offen offset:2048
    buffer_load_dwordx4 v[196:199], v6, s[48:51], s60 offen offset:3072
    s_cmp_eq_u32 s59, 0
    s_cbranch_scc1 wx_20
    s_add_u32 s60, s58, 0
    buffer_load_dwordx4 v[136:139], v6, s[48:51], s60 offen offset:0
    buffer_load_dwordx4 v[140:143], v6, s[48:51], s60 offen offset:1024
    buffer_load_dwordx4 v[144:147], v6, s[48:51], s60 offen offset:2048
    buffer_load_dwordx4 v[148:151], v6, s[48:51], s60 offen offset:3072
    s_cmp_eq_u32 s59, 1
    s_cbranch_scc1 wx_20
    s_add_u32 s60, s58, 4096
    buffer_load_dwordx4 v[152:155], v6, s[48:51], s60 offen offset:0
    buffer_load_dwordx4 v[156:159], v6, s[48:51], s60 offen offset:1024
    buffer_load_dwordx4 v[160:163], v6, s[48:51], s60 offen offset:2048
    buffer_load_dwordx4 v[164:167], v6, s[48:51], s60 offen offset:3072
    s_cmp_eq_u32 s59, 2
    s_cbranch_scc1 wx_20
    s_add_u32 s60, s58, 8192
    buffer_load_dwordx4 v[168:171], v6, s[48:51], s60 offen offset:0
    buffer_load_dwordx4 v[172:175], v6, s[48:51], s60 offen offset:1024
    buffer_load_dwordx4 v[176:179], v6, s[48:51], s60 offen offset:2048
    buffer_load_dwordx4 v[180:183], v6, s[48:51], s60 offen offset:3072
wx_20:
fn_15:
    s_and_b32 s52, s29, 7
    v_xor_b32 v12, s52, v4
    v_lshlrev_b32 v12, 2, v12
    v_and_b32 v6, 3, v1
    v_add_lshl_u32 v12, v12, v6, 9
    v_lshlrev_b32 v13, 9, v4
    v_lshl_add_u32 v13, v5, 4, v13
    v_lshrrev_b32 v11, 4, v1
    v_lshlrev_b32 v11, 3, v11
    v_lshl_add_u32 v11, v5, 5, v11
    s_lshl_b32 s52, s29, 4
    s_add_u32 s52, s52, 655360
    s_lshl_b32 s53, s31, 14
    s_add_u32 s53, s53, s52
    s_lshl_b32 s58, s29, 3
    s_add_u32 s58, s58, s30
    s_lshl_b32 s58, s58, 14
    s_lshl_b32 s52, s31, 12
    s_add_u32 s58, s58, s52
    s_add_u32 s58, s58, 4194304
    s_lshl_b32 s52, s28, 8
    s_add_u32 s52, s52, 149504
    v_add_u32 v11, s52, v11
    s_lshl_b32 s52, s28, 3
    v_add_u32 v14, s52, v2
    s_cmp_lg_u32 s17, 0
    s_cbranch_scc1 pw_21
    s_waitcnt vmcnt(16)
    v_perm_b32 v64, v76, v72, s96
    v_perm_b32 v65, v76, v72, s97
    v_perm_b32 v66, v77, v73, s96
    v_perm_b32 v67, v77, v73, s97
    v_perm_b32 v68, v78, v74, s96
    v_perm_b32 v69, v78, v74, s97
    v_perm_b32 v70, v79, v75, s96
    v_perm_b32 v71, v79, v75, s97
    v_perm_b32 v72, v84, v80, s96
    v_perm_b32 v73, v84, v80, s97
    v_perm_b32 v74, v85, v81, s96
    v_perm_b32 v75, v85, v81, s97
    v_perm_b32 v76, v86, v82, s96
    v_perm_b32 v77, v86, v82, s97
    v_perm_b32 v78, v87, v83, s96
    v_perm_b32 v79, v87, v83, s97
    v_perm_b32 v80, v92, v88, s96
    v_perm_b32 v81, v92, v88, s97
    v_perm_b32 v82, v93, v89, s96
    v_perm_b32 v83, v93, v89, s97
    v_perm_b32 v84, v94, v90, s96
    v_perm_b32 v85, v94, v90, s97
    v_perm_b32 v86, v95, v91, s96
    v_perm_b32 v87, v95, v91, s97
    v_perm_b32 v88, v100, v96, s96
    v_perm_b32 v89, v100, v96, s97
    v_perm_b32 v90, v101, v97, s96
    v_perm_b32 v91, v101, v97, s97
    v_perm_b32 v92, v102, v98, s96
    v_perm_b32 v93, v102, v98, s97
    v_perm_b32 v94, v103, v99, s96
    v_perm_b32 v95, v103, v99, s97
    v_perm_b32 v96, v108, v104, s96
    v_perm_b32 v97, v108, v104, s97
    v_perm_b32 v98, v109, v105, s96
    v_perm_b32 v99, v109, v105, s97
    v_perm_b32 v100, v110, v106, s96
    v_perm_b32 v101, v110, v106, s97
    v_perm_b32 v102, v111, v107, s96
    v_perm_b32 v103, v111, v107, s97
    v_perm_b32 v104, v116, v112, s96
    v_perm_b32 v105, v116, v112, s97
    v_perm_b32 v106, v117, v113, s96
    v_perm_b32 v107, v117, v113, s97
    v_perm_b32 v108, v118, v114, s96
    v_perm_b32 v109, v118, v114, s97
    v_perm_b32 v110, v119, v115, s96
    v_perm_b32 v111, v119, v115, s97
    v_perm_b32 v112, v124, v120, s96
    v_perm_b32 v113, v124, v120, s97
    v_perm_b32 v114, v125, v121, s96
    v_perm_b32 v115, v125, v121, s97
    v_perm_b32 v116, v126, v122, s96
    v_perm_b32 v117, v126, v122, s97
    v_perm_b32 v118, v127, v123, s96
    v_perm_b32 v119, v127, v123, s97
    v_perm_b32 v120, v132, v128, s96
    v_perm_b32 v121, v132, v128, s97
    v_perm_b32 v122, v133, v129, s96
    v_perm_b32 v123, v133, v129, s97
    v_perm_b32 v124, v134, v130, s96
    v_perm_b32 v125, v134, v130, s97
    v_perm_b32 v126, v135, v131, s96
    v_perm_b32 v127, v135, v131, s97
pw_21:
    v_lshrrev_b32 v21, 4, v1
    v_lshlrev_b32 v21, 17, v21
    v_lshl_add_u32 v21, v5, 4, v21
    s_lshl_b32 s56, s28, 2
    s_xor_b32 s56, s56, s3
    s_lshl_b32 s56, s56, 7
    s_lshl_b32 s57, s28, 14
    s_add_u32 s59, s56, s57
    s_add_u32 s59, s59, 2097152
    v_lshl_add_u32 v22, v4, 2, v2
    v_and_b32 v6, 3, v1
    v_add_u32 v6, s0, v6
    v_lshl_add_u32 v15, v6, 3, v2
    s_lshl_b32 s54, s0, 8
    s_add_u32 s54, s54, 149504
    v_lshl_add_u32 v7, v1, 2, s54
    v_lshlrev_b32 v23, 10, v4
    v_lshl_add_u32 v23, v5, 4, v23
    s_lshl_b32 s60, s29, 13
    s_lshl_b32 s61, s30, 7
    s_add_u32 s61, s61, s60
    s_add_u32 s61, s61, 1048576
    s_lshl_b32 s54, s30, 10
    s_add_u32 s60, s60, s54
    s_add_u32 s60, s60, 1048576
    s_lshr_b32 s54, s28, 2
    s_lshl_b32 s54, s54, 5
    s_add_u32 s54, s54, 153600
    v_lshl_add_u32 v20, v5, 2, s54
    v_lshl_add_u32 v22, v4, 6, v2
    v_and_b32 v23, 15, v1
    v_lshlrev_b32 v23, 5, v23
    v_lshrrev_b32 v6, 4, v1
    v_lshl_add_u32 v23, v6, 3, v23
    s_lshl_b32 s54, s0, 7
    s_add_u32 s54, s54, 153600
    v_add_u32 v23, s54, v23
    s_cmp_lg_u32 s28, 7
    s_cbranch_scc1 h2_22
    s_lshl_b32 s52, s34, 13
    s_add_u32 s52, s52, 721024
    v_and_b32 v10, 15, v1
    v_lshlrev_b32 v10, 9, v10
    s_mov_b32 s98, 200000
    s_mov_b64 exec, 0xffff
hi_23:
    s_sleep 1
    buffer_load_dwordx2 v[8:9], v10, s[36:39], s52 offen sc1
    s_waitcnt vmcnt(0)
    v_cmp_eq_u64 vcc, s[32:33], v[8:9]
    s_nop 0
    s_bcnt1_i32_b64 s101, vcc
    s_cmp_ge_u32 s101, 8
    s_cbranch_scc1 hid_24
    s_sub_u32 s98, s98, 1
    s_cmp_lg_u32 s98, 0
    s_cbranch_scc1 hi_23
hid_24:
    s_mov_b64 exec, -1
    v_mov_b32 v8, 1
    ds_write_b32 v2, v8 offset:12
h2_22:
    s_mov_b32 s98, 3200000
wf_25:
    ds_read_b32 v8, v2 offset:12
    s_waitcnt lgkmcnt(0)
    v_readfirstlane_b32 s101, v8
    s_nop 0
    s_cmp_lg_u32 s101, 0
    s_cbranch_scc1 wfd_26
    s_sleep 1
    s_sub_u32 s98, s98, 1
    s_cmp_lg_u32 s98, 0
    s_cbranch_scc1 wf_25
wfd_26:
    s_mov_b32 s98, 200000
ml_27:
    buffer_load_dwordx4 v[28:31], v12, s[36:39], s53 offen sc1
    s_waitcnt vmcnt(0)
mlc_29:
    v_cmp_eq_u64 vcc, s[32:33], v[30:31]
    s_nop 0
    s_cmp_eq_u64 vcc, -1
    s_cbranch_scc1 mld_28
    s_sleep 2
    s_sub_u32 s98, s98, 1
    s_cmp_lg_u32 s98, 0
    s_cbranch_scc1 ml_27
mld_28:
    v_mov_b32 v16, v28
    s_nop 1
    v_max_f32_dpp v16, v16, v16 quad_perm:[1,0,3,2] row_mask:0xf bank_mask:0xf
    s_nop 1
    v_max_f32_dpp v16, v16, v16 quad_perm:[2,3,0,1] row_mask:0xf bank_mask:0xf
    s_nop 1
    v_max_f32_dpp v16, v16, v16 row_mirror row_mask:0xf bank_mask:0xf
    v_mov_b32 v17, v16
    s_nop 1
    v_permlane16_swap_b32 v17, v16
    v_max_f32 v16, v16, v17
    v_mov_b32 v17, v16
    s_nop 1
    v_permlane32_swap_b32 v17, v16
    v_max_f32 v16, v16, v17
    v_sub_f32 v8, v28, v16
    v_exp_f32 v8, v8
    s_nop 0
    v_mul_f32 v17, v8, v29
    v_mov_b32_dpp v24, v8 quad_perm:[0,0,0,0] row_mask:0xf bank_mask:0xf
    v_mov_b32_dpp v25, v8 quad_perm:[1,1,1,1] row_mask:0xf bank_mask:0xf
    v_mov_b32_dpp v26, v8 quad_perm:[2,2,2,2] row_mask:0xf bank_mask:0xf
    v_mov_b32_dpp v27, v8 quad_perm:[3,3,3,3] row_mask:0xf bank_mask:0xf
    v_add_f32_dpp v17, v17, v17 quad_perm:[1,0,3,2] row_mask:0xf bank_mask:0xf
    s_nop 1
    v_add_f32_dpp v17, v17, v17 quad_perm:[2,3,0,1] row_mask:0xf bank_mask:0xf
    s_nop 1
    v_add_f32_dpp v17, v17, v17 row_mirror row_mask:0xf bank_mask:0xf
    v_mov_b32 v18, v17
    s_nop 1
    v_permlane16_swap_b32 v18, v17
    v_add_f32 v17, v17, v18
    v_mov_b32 v18, v17
    s_nop 1
    v_permlane32_swap_b32 v18, v17
    v_add_f32 v17, v17, v18
    ds_write_b64 v14, v[16:17] offset:1344
    s_lshl_b32 s52, s28, 2
    v_add_u32 v18, s52, v2
    v_mov_b32 v19, 1
    ds_write_b32 v18, v19 offset:112
    buffer_load_dwordx4 v[48:51], v13, s[36:39], s58 offen offset:0 sc1
    buffer_load_dwordx4 v[52:55], v13, s[36:39], s58 offen offset:128 sc1
    buffer_load_dwordx4 v[56:59], v13, s[36:39], s58 offen offset:256 sc1
    buffer_load_dwordx4 v[60:63], v13, s[36:39], s58 offen offset:384 sc1
    v_perm_b32 v128, v140, v136, s96
    v_perm_b32 v129, v140, v136, s97
    v_perm_b32 v130, v141, v137, s96
    v_perm_b32 v131, v141, v137, s97
    v_perm_b32 v132, v142, v138, s96
    v_perm_b32 v133, v142, v138, s97
    v_perm_b32 v134, v143, v139, s96
    v_perm_b32 v135, v143, v139, s97
    v_perm_b32 v136, v148, v144, s96
    v_perm_b32 v137, v148, v144, s97
    v_perm_b32 v138, v149, v145, s96
    v_perm_b32 v139, v149, v145, s97
    v_perm_b32 v140, v150, v146, s96
    v_perm_b32 v141, v150, v146, s97
    v_perm_b32 v142, v151, v147, s96
    v_perm_b32 v143, v151, v147, s97
    v_perm_b32 v144, v156, v152, s96
    v_perm_b32 v145, v156, v152, s97
    v_perm_b32 v146, v157, v153, s96
    v_perm_b32 v147, v157, v153, s97
    v_perm_b32 v148, v158, v154, s96
    v_perm_b32 v149, v158, v154, s97
    v_perm_b32 v150, v159, v155, s96
    v_perm_b32 v151, v159, v155, s97
    v_perm_b32 v152, v164, v160, s96
    v_perm_b32 v153, v164, v160, s97
    v_perm_b32 v154, v165, v161, s96
    v_perm_b32 v155, v165, v161, s97
    v_perm_b32 v156, v166, v162, s96
    v_perm_b32 v157, v166, v162, s97
    v_perm_b32 v158, v167, v163, s96
    v_perm_b32 v159, v167, v163, s97
    v_perm_b32 v160, v172, v168, s96
    v_perm_b32 v161, v172, v168, s97
    v_perm_b32 v162, v173, v169, s96
    v_perm_b32 v163, v173, v169, s97
    v_perm_b32 v164, v174, v170, s96
    v_perm_b32 v165, v174, v170, s97
    v_perm_b32 v166, v175, v171, s96
    v_perm_b32 v167, v175, v171, s97
    v_perm_b32 v168, v180, v176, s96
    v_perm_b32 v169, v180, v176, s97
    v_perm_b32 v170, v181, v177, s96
    v_perm_b32 v171, v181, v177, s97
    v_perm_b32 v172, v182, v178, s96
    v_perm_b32 v173, v182, v178, s97
    v_perm_b32 v174, v183, v179, s96
    v_perm_b32 v175, v183, v179, s97
    v_perm_b32 v176, v188, v184, s96
    v_perm_b32 v177, v188, v184, s97
    v_perm_b32 v178, v189, v185, s96
    v_perm_b32 v179, v189, v185, s97
    v_perm_b32 v180, v190, v186, s96
    v_perm_b32 v181, v190, v186, s97
    v_perm_b32 v182, v191, v187, s96
    v_perm_b32 v183, v191, v187, s97
    v_perm_b32 v184, v196, v192, s96
    v_perm_b32 v185, v196, v192, s97
    v_perm_b32 v186, v197, v193, s96
    v_perm_b32 v187, v197, v193, s97
    v_perm_b32 v188, v198, v194, s96
    v_perm_b32 v189, v198, v194, s97
    v_perm_b32 v190, v199, v195, s96
    v_perm_b32 v191, v199, v195, s97
    s_cmp_lg_u32 s17, 0
    s_cbranch_scc1 nf_33
    v_sub_u32 v10, v15, v2
    v_lshrrev_b32 v10, 1, v10
    v_add_u32 v10, v10, v2
    s_mov_b32 s98, 3200000
st_34:
    ds_read_b32 v18, v10 offset:112
    ds_read_b64 v[16:17], v15 offset:1344
    s_waitcnt lgkmcnt(0)
    v_cmp_ne_u32 vcc, 0, v18
    s_nop 0
    s_cmp_eq_u64 vcc, -1
    s_cbranch_scc1 std_35
    s_sub_u32 s98, s98, 1
    s_cmp_lg_u32 s98, 0
    s_cbranch_scc1 st_34
std_35:
    v_max_f32_dpp v18, v16, v16 quad_perm:[1,0,3,2] row_mask:0xf bank_mask:0xf
    s_nop 1
    v_max_f32_dpp v18, v18, v18 quad_perm:[2,3,0,1] row_mask:0xf bank_mask:0xf
    v_sub_f32 v16, v16, v18
    v_exp_f32 v16, v16
    s_nop 0
    v_mul_f32 v17, v16, v17
    s_nop 1
    v_add_f32_dpp v17, v17, v17 quad_perm:[1,0,3,2] row_mask:0xf bank_mask:0xf
    s_nop 1
    v_add_f32_dpp v17, v17, v17 quad_perm:[2,3,0,1] row_mask:0xf bank_mask:0xf
    v_rcp_f32 v17, v17
    s_nop 0
    v_mul_f32 v16, v16, v17
nf_33:
    v_mov_b32 v30, 0x8000
    s_mov_b32 s57, 0xffff0000
    s_mov_b32 s98, 200000
    s_branch opc_32
op_30:
    buffer_load_dwordx4 v[48:51], v13, s[36:39], s58 offen offset:0 sc1
    buffer_load_dwordx4 v[52:55], v13, s[36:39], s58 offen offset:128 sc1
    buffer_load_dwordx4 v[56:59], v13, s[36:39], s58 offen offset:256 sc1
    buffer_load_dwordx4 v[60:63], v13, s[36:39], s58 offen offset:384 sc1
opc_32:
    s_waitcnt vmcnt(3)
    v_xor_b32 v48, v48, v240
    v_xor_b32 v49, v49, v241
    v_xor_b32 v50, v50, v242
    v_xor_b32 v51, v51, v243
    v_or3_b32 v28, v48, v49, v50
    v_mov_b32 v29, v51
    v_lshl_or_b32 v40, v48, 16, v30
    v_and_or_b32 v41, v48, s57, v30
    v_lshl_or_b32 v42, v49, 16, v30
    v_and_or_b32 v43, v49, s57, v30
    v_lshl_or_b32 v44, v50, 16, v30
    v_and_or_b32 v45, v50, s57, v30
    v_lshl_or_b32 v46, v51, 16, v30
    v_and_or_b32 v47, v51, s57, v30
    v_mul_f32 v32, v40, v24
    v_mul_f32 v33, v41, v24
    v_mul_f32 v34, v42, v24
    v_mul_f32 v35, v43, v24
    v_mul_f32 v36, v44, v24
    v_mul_f32 v37, v45, v24
    v_mul_f32 v38, v46, v24
    v_mul_f32 v39, v47, v24
    s_waitcnt vmcnt(2)
    v_xor_b32 v52, v52, v240
    v_xor_b32 v53, v53, v241
    v_xor_b32 v54, v54, v242
    v_xor_b32 v55, v55, v243
    v_or3_b32 v28, v28, v52, v53
    v_or3_b32 v29, v29, v54, v55
    v_lshl_or_b32 v40, v52, 16, v30
    v_and_or_b32 v41, v52, s57, v30
    v_lshl_or_b32 v42, v53, 16, v30
    v_and_or_b32 v43, v53, s57, v30
    v_lshl_or_b32 v44, v54, 16, v30
    v_and_or_b32 v45, v54, s57, v30
    v_lshl_or_b32 v46, v55, 16, v30
    v_and_or_b32 v47, v55, s57, v30
    v_fmac_f32 v32, v40, v25
    v_fmac_f32 v33, v41, v25
    v_fmac_f32 v34, v42, v25
    v_fmac_f32 v35, v43, v25
    v_fmac_f32 v36, v44, v25
    v_fmac_f32 v37, v45, v25
    v_fmac_f32 v38, v46, v25
    v_fmac_f32 v39, v47, v25
    s_waitcnt vmcnt(1)
    v_xor_b32 v56, v56, v240
    v_xor_b32 v57, v57, v241
    v_xor_b32 v58, v58, v242
    v_xor_b32 v59, v59, v243
    v_or3_b32 v28, v28, v56, v57
    v_or3_b32 v29, v29, v58, v59
    v_lshl_or_b32 v40, v56, 16, v30
    v_and_or_b32 v41, v56, s57, v30
    v_lshl_or_b32 v42, v57, 16, v30
    v_and_or_b32 v43, v57, s57, v30
    v_lshl_or_b32 v44, v58, 16, v30
    v_and_or_b32 v45, v58, s57, v30
    v_lshl_or_b32 v46, v59, 16, v30
    v_and_or_b32 v47, v59, s57, v30
    v_fmac_f32 v32, v40, v26
    v_fmac_f32 v33, v41, v26
    v_fmac_f32 v34, v42, v26
    v_fmac_f32 v35, v43, v26
    v_fmac_f32 v36, v44, v26
    v_fmac_f32 v37, v45, v26
    v_fmac_f32 v38, v46, v26
    v_fmac_f32 v39, v47, v26
    s_waitcnt vmcnt(0)
    v_xor_b32 v60, v60, v240
    v_xor_b32 v61, v61, v241
    v_xor_b32 v62, v62, v242
    v_xor_b32 v63, v63, v243
    v_or3_b32 v28, v28, v60, v61
    v_or3_b32 v29, v29, v62, v63
    v_or_b32 v28, v28, v29
    v_and_b32 v28, s62, v28
    v_cmp_ne_u32 vcc, 0, v28
    v_lshl_or_b32 v40, v60, 16, v30
    v_and_or_b32 v41, v60, s57, v30
    v_lshl_or_b32 v42, v61, 16, v30
    v_and_or_b32 v43, v61, s57, v30
    v_lshl_or_b32 v44, v62, 16, v30
    v_and_or_b32 v45, v62, s57, v30
    v_lshl_or_b32 v46, v63, 16, v30
    v_and_or_b32 v47, v63, s57, v30
    v_fmac_f32 v32, v40, v27
    v_fmac_f32 v33, v41, v27
    v_fmac_f32 v34, v42, v27
    v_fmac_f32 v35, v43, v27
    v_fmac_f32 v36, v44, v27
    v_fmac_f32 v37, v45, v27
    v_fmac_f32 v38, v46, v27
    v_fmac_f32 v39, v47, v27
    s_cbranch_vccz opd_31
    s_sub_u32 s98, s98, 1
    s_cmp_lg_u32 s98, 0
    s_cbranch_scc1 op_30
opd_31:
    v_permlane32_swap_b32 v32, v36
    v_permlane32_swap_b32 v33, v37
    v_permlane32_swap_b32 v34, v38
    v_permlane32_swap_b32 v35, v39
    v_add_f32 v32, v32, v36
    v_add_f32 v33, v33, v37
    v_add_f32 v34, v34, v38
    v_add_f32 v35, v35, v39
    s_nop 0
    v_permlane16_swap_b32 v32, v34
    v_permlane16_swap_b32 v33, v35
    v_add_f32 v32, v32, v34
    v_add_f32 v33, v33, v35
    s_nop 0
    v_add_f32_dpp v32, v32, v32 row_ror:8 row_mask:0xf bank_mask:0xf
    v_add_f32_dpp v33, v33, v33 row_ror:8 row_mask:0xf bank_mask:0xf
    ds_write_b64 v11, v[32:33]
    v_mov_b32 v40, 0
    v_mov_b32 v41, 0
    v_mov_b32 v42, 0
    v_mov_b32 v43, 0
    v_mov_b32 v44, 0
    v_mov_b32 v45, 0
    v_mov_b32 v46, 0
    v_mov_b32 v47, 0
    s_waitcnt lgkmcnt(0)
    s_barrier
    s_cmp_lg_u32 s28, 3
    s_cbranch_scc1 ne_36
    s_cmp_lg_u32 s2, 0
    s_cbranch_scc1 ne_36
    s_xor_b32 s52, s24, 0xc6a4a793
    s_xor_b32 s53, s25, 0x3c1b69d2
    v_mov_b32 v18, s52
    v_mov_b32 v19, s53
    v_mov_b32 v16, s32
    v_mov_b32 v17, s33
    v_mov_b32 v10, 0
    s_mov_b64 exec, 1
    buffer_store_dwordx4 v[16:19], v10, s[36:39], 0 offen sc1
    s_mov_b64 exec, -1
ne_36:
    s_cmp_lg_u32 s17, 0
    s_cbranch_scc1 b2_37
    ds_read_b32 v8, v7 offset:0
    ds_read_b32 v9, v7 offset:256
    ds_read_b32 v10, v7 offset:512
    ds_read_b32 v11, v7 offset:768
    s_waitcnt lgkmcnt(0)
    v_mul_f32_dpp v8, v16, v8 quad_perm:[0,0,0,0] row_mask:0xf bank_mask:0xf
    v_mul_f32_dpp v9, v16, v9 quad_perm:[1,1,1,1] row_mask:0xf bank_mask:0xf
    s_nop 0
    v_fmac_f32_dpp v8, v16, v10 quad_perm:[2,2,2,2] row_mask:0xf bank_mask:0xf
    v_fmac_f32_dpp v9, v16, v11 quad_perm:[3,3,3,3] row_mask:0xf bank_mask:0xf
    v_add_f32 v8, v8, v9
    s_nop 1
    v_mov_b32_dpp v9, v8 quad_perm:[1,0,3,2] row_mask:0xf bank_mask:0xf
    v_cvt_pk_bf16_f32 v8, v8, v9
    s_nop 1
    v_dot2c_f32_bf16_dpp v40, v8, v64 row_newbcast:0 row_mask:0xf bank_mask:0xf
    v_dot2c_f32_bf16_dpp v41, v8, v65 row_newbcast:0 row_mask:0xf bank_mask:0xf
    v_dot2c_f32_bf16_dpp v42, v8, v66 row_newbcast:0 row_mask:0xf bank_mask:0xf
    v_dot2c_f32_bf16_dpp v43, v8, v67 row_newbcast:0 row_mask:0xf bank_mask:0xf
    v_dot2c_f32_bf16_dpp v44, v8, v68 row_newbcast:0 row_mask:0xf bank_mask:0xf
    v_dot2c_f32_bf16_dpp v45, v8, v69 row_newbcast:0 row_mask:0xf bank_mask:0xf
    v_dot2c_f32_bf16_dpp v46, v8, v70 row_newbcast:0 row_mask:0xf bank_mask:0xf
    v_dot2c_f32_bf16_dpp v47, v8, v71 row_newbcast:0 row_mask:0xf bank_mask:0xf
    v_dot2c_f32_bf16_dpp v40, v8, v72 row_newbcast:2 row_mask:0xf bank_mask:0xf
    v_dot2c_f32_bf16_dpp v41, v8, v73 row_newbcast:2 row_mask:0xf bank_mask:0xf
    v_dot2c_f32_bf16_dpp v42, v8, v74 row_newbcast:2 row_mask:0xf bank_mask:0xf
    v_dot2c_f32_bf16_dpp v43, v8, v75 row_newbcast:2 row_mask:0xf bank_mask:0xf
    v_dot2c_f32_bf16_dpp v44, v8, v76 row_newbcast:2 row_mask:0xf bank_mask:0xf
    v_dot2c_f32_bf16_dpp v45, v8, v77 row_newbcast:2 row_mask:0xf bank_mask:0xf
    v_dot2c_f32_bf16_dpp v46, v8, v78 row_newbcast:2 row_mask:0xf bank_mask:0xf
    v_dot2c_f32_bf16_dpp v47, v8, v79 row_newbcast:2 row_mask:0xf bank_mask:0xf
    v_dot2c_f32_bf16_dpp v40, v8, v80 row_newbcast:4 row_mask:0xf bank_mask:0xf
    v_dot2c_f32_bf16_dpp v41, v8, v81 row_newbcast:4 row_mask:0xf bank_mask:0xf
    v_dot2c_f32_bf16_dpp v42, v8, v82 row_newbcast:4 row_mask:0xf bank_mask:0xf
    v_dot2c_f32_bf16_dpp v43, v8, v83 row_newbcast:4 row_mask:0xf bank_mask:0xf
    v_dot2c_f32_bf16_dpp v44, v8, v84 row_newbcast:4 row_mask:0xf bank_mask:0xf
    v_dot2c_f32_bf16_dpp v45, v8, v85 row_newbcast:4 row_mask:0xf bank_mask:0xf
    v_dot2c_f32_bf16_dpp v46, v8, v86 row_newbcast:4 row_mask:0xf bank_mask:0xf
    v_dot2c_f32_bf16_dpp v47, v8, v87 row_newbcast:4 row_mask:0xf bank_mask:0xf
    v_dot2c_f32_bf16_dpp v40, v8, v88 row_newbcast:6 row_mask:0xf bank_mask:0xf
    v_dot2c_f32_bf16_dpp v41, v8, v89 row_newbcast:6 row_mask:0xf bank_mask:0xf
    v_dot2c_f32_bf16_dpp v42, v8, v90 row_newbcast:6 row_mask:0xf bank_mask:0xf
    v_dot2c_f32_bf16_dpp v43, v8, v91 row_newbcast:6 row_mask:0xf bank_mask:0xf
    v_dot2c_f32_bf16_dpp v44, v8, v92 row_newbcast:6 row_mask:0xf bank_mask:0xf
    v_dot2c_f32_bf16_dpp v45, v8, v93 row_newbcast:6 row_mask:0xf bank_mask:0xf
    v_dot2c_f32_bf16_dpp v46, v8, v94 row_newbcast:6 row_mask:0xf bank_mask:0xf
    v_dot2c_f32_bf16_dpp v47, v8, v95 row_newbcast:6 row_mask:0xf bank_mask:0xf
    v_dot2c_f32_bf16_dpp v40, v8, v96 row_newbcast:8 row_mask:0xf bank_mask:0xf
    v_dot2c_f32_bf16_dpp v41, v8, v97 row_newbcast:8 row_mask:0xf bank_mask:0xf
    v_dot2c_f32_bf16_dpp v42, v8, v98 row_newbcast:8 row_mask:0xf bank_mask:0xf
    v_dot2c_f32_bf16_dpp v43, v8, v99 row_newbcast:8 row_mask:0xf bank_mask:0xf
    v_dot2c_f32_bf16_dpp v44, v8, v100 row_newbcast:8 row_mask:0xf bank_mask:0xf
    v_dot2c_f32_bf16_dpp v45, v8, v101 row_newbcast:8 row_mask:0xf bank_mask:0xf
    v_dot2c_f32_bf16_dpp v46, v8, v102 row_newbcast:8 row_mask:0xf bank_mask:0xf
    v_dot2c_f32_bf16_dpp v47, v8, v103 row_newbcast:8 row_mask:0xf bank_mask:0xf
    v_dot2c_f32_bf16_dpp v40, v8, v104 row_newbcast:10 row_mask:0xf bank_mask:0xf
    v_dot2c_f32_bf16_dpp v41, v8, v105 row_newbcast:10 row_mask:0xf bank_mask:0xf
    v_dot2c_f32_bf16_dpp v42, v8, v106 row_newbcast:10 row_mask:0xf bank_mask:0xf
    v_dot2c_f32_bf16_dpp v43, v8, v107 row_newbcast:10 row_mask:0xf bank_mask:0xf
    v_dot2c_f32_bf16_dpp v44, v8, v108 row_newbcast:10 row_mask:0xf bank_mask:0xf
    v_dot2c_f32_bf16_dpp v45, v8, v109 row_newbcast:10 row_mask:0xf bank_mask:0xf
    v_dot2c_f32_bf16_dpp v46, v8, v110 row_newbcast:10 row_mask:0xf bank_mask:0xf
    v_dot2c_f32_bf16_dpp v47, v8, v111 row_newbcast:10 row_mask:0xf bank_mask:0xf
    v_dot2c_f32_bf16_dpp v40, v8, v112 row_newbcast:12 row_mask:0xf bank_mask:0xf
    v_dot2c_f32_bf16_dpp v41, v8, v113 row_newbcast:12 row_mask:0xf bank_mask:0xf
    v_dot2c_f32_bf16_dpp v42, v8, v114 row_newbcast:12 row_mask:0xf bank_mask:0xf
    v_dot2c_f32_bf16_dpp v43, v8, v115 row_newbcast:12 row_mask:0xf bank_mask:0xf
    v_dot2c_f32_bf16_dpp v44, v8, v116 row_newbcast:12 row_mask:0xf bank_mask:0xf
    v_dot2c_f32_bf16_dpp v45, v8, v117 row_newbcast:12 row_mask:0xf bank_mask:0xf
    v_dot2c_f32_bf16_dpp v46, v8, v118 row_newbcast:12 row_mask:0xf bank_mask:0xf
    v_dot2c_f32_bf16_dpp v47, v8, v119 row_newbcast:12 row_mask:0xf bank_mask:0xf
    v_dot2c_f32_bf16_dpp v40, v8, v120 row_newbcast:14 row_mask:0xf bank_mask:0xf
    v_dot2c_f32_bf16_dpp v41, v8, v121 row_newbcast:14 row_mask:0xf bank_mask:0xf
    v_dot2c_f32_bf16_dpp v42, v8, v122 row_newbcast:14 row_mask:0xf bank_mask:0xf
    v_dot2c_f32_bf16_dpp v43, v8, v123 row_newbcast:14 row_mask:0xf bank_mask:0xf
    v_dot2c_f32_bf16_dpp v44, v8, v124 row_newbcast:14 row_mask:0xf bank_mask:0xf
    v_dot2c_f32_bf16_dpp v45, v8, v125 row_newbcast:14 row_mask:0xf bank_mask:0xf
    v_dot2c_f32_bf16_dpp v46, v8, v126 row_newbcast:14 row_mask:0xf bank_mask:0xf
    v_dot2c_f32_bf16_dpp v47, v8, v127 row_newbcast:14 row_mask:0xf bank_mask:0xf
    v_permlane32_swap_b32 v40, v44
    v_permlane32_swap_b32 v41, v45
    v_permlane32_swap_b32 v42, v46
    v_permlane32_swap_b32 v43, v47
    v_add_f32 v40, v40, v44
    v_add_f32 v41, v41, v45
    v_add_f32 v42, v42, v46
    v_add_f32 v43, v43, v47
    s_nop 0
    v_permlane16_swap_b32 v40, v42
    v_permlane16_swap_b32 v41, v43
    v_add_f32 v40, v40, v42
    v_add_f32 v41, v41, v43
    ds_write_b64 v23, v[40:41]
b2_37:
    s_waitcnt lgkmcnt(0)
    s_barrier
    ds_read_b128 v[48:51], v22 offset:6144
    ds_read_b128 v[64:67], v22 offset:6656
    ds_read_b128 v[52:55], v22 offset:6160
    ds_read_b128 v[68:71], v22 offset:6672
    ds_read_b128 v[56:59], v22 offset:6176
    ds_read_b128 v[72:75], v22 offset:6688
    ds_read_b128 v[60:63], v22 offset:6192
    ds_read_b128 v[76:79], v22 offset:6704
    s_waitcnt lgkmcnt(6)
    v_add_f32 v48, v48, v64
    v_add_f32 v49, v49, v65
    v_add_f32 v50, v50, v66
    v_add_f32 v51, v51, v67
    v_cvt_pk_bf16_f32 v8, v48, v49
    v_cvt_pk_bf16_f32 v9, v50, v51
    v_dot2_f32_bf16 v32, v128, v8, 0
    v_dot2_f32_bf16 v33, v129, v8, 0
    v_dot2_f32_bf16 v34, v130, v8, 0
    v_dot2_f32_bf16 v35, v131, v8, 0
    v_dot2_f32_bf16 v36, v132, v8, 0
    v_dot2_f32_bf16 v37, v133, v8, 0
    v_dot2_f32_bf16 v38, v134, v8, 0
    v_dot2_f32_bf16 v39, v135, v8, 0
    v_dot2c_f32_bf16 v32, v136, v9
    v_dot2c_f32_bf16 v33, v137, v9
    v_dot2c_f32_bf16 v34, v138, v9
    v_dot2c_f32_bf16 v35, v139, v9
    v_dot2c_f32_bf16 v36, v140, v9
    v_dot2c_f32_bf16 v37, v141, v9
    v_dot2c_f32_bf16 v38, v142, v9
    v_dot2c_f32_bf16 v39, v143, v9
    s_waitcnt lgkmcnt(4)
    v_add_f32 v52, v52, v68
    v_add_f32 v53, v53, v69
    v_add_f32 v54, v54, v70
    v_add_f32 v55, v55, v71
    v_cvt_pk_bf16_f32 v10, v52, v53
    v_cvt_pk_bf16_f32 v11, v54, v55
    v_dot2c_f32_bf16 v32, v144, v10
    v_dot2c_f32_bf16 v33, v145, v10
    v_dot2c_f32_bf16 v34, v146, v10
    v_dot2c_f32_bf16 v35, v147, v10
    v_dot2c_f32_bf16 v36, v148, v10
    v_dot2c_f32_bf16 v37, v149, v10
    v_dot2c_f32_bf16 v38, v150, v10
    v_dot2c_f32_bf16 v39, v151, v10
    v_dot2c_f32_bf16 v32, v152, v11
    v_dot2c_f32_bf16 v33, v153, v11
    v_dot2c_f32_bf16 v34, v154, v11
    v_dot2c_f32_bf16 v35, v155, v11
    v_dot2c_f32_bf16 v36, v156, v11
    v_dot2c_f32_bf16 v37, v157, v11
    v_dot2c_f32_bf16 v38, v158, v11
    v_dot2c_f32_bf16 v39, v159, v11
    s_waitcnt lgkmcnt(2)
    v_add_f32 v56, v56, v72
    v_add_f32 v57, v57, v73
    v_add_f32 v58, v58, v74
    v_add_f32 v59, v59, v75
    v_cvt_pk_bf16_f32 v12, v56, v57
    v_cvt_pk_bf16_f32 v13, v58, v59
    v_dot2c_f32_bf16 v32, v160, v12
    v_dot2c_f32_bf16 v33, v161, v12
    v_dot2c_f32_bf16 v34, v162, v12
    v_dot2c_f32_bf16 v35, v163, v12
    v_dot2c_f32_bf16 v36, v164, v12
    v_dot2c_f32_bf16 v37, v165, v12
    v_dot2c_f32_bf16 v38, v166, v12
    v_dot2c_f32_bf16 v39, v167, v12
    v_dot2c_f32_bf16 v32, v168, v13
    v_dot2c_f32_bf16 v33, v169, v13
    v_dot2c_f32_bf16 v34, v170, v13
    v_dot2c_f32_bf16 v35, v171, v13
    v_dot2c_f32_bf16 v36, v172, v13
    v_dot2c_f32_bf16 v37, v173, v13
    v_dot2c_f32_bf16 v38, v174, v13
    v_dot2c_f32_bf16 v39, v175, v13
    s_waitcnt lgkmcnt(0)
    v_add_f32 v60, v60, v76
    v_add_f32 v61, v61, v77
    v_add_f32 v62, v62, v78
    v_add_f32 v63, v63, v79
    v_cvt_pk_bf16_f32 v14, v60, v61
    v_cvt_pk_bf16_f32 v15, v62, v63
    v_dot2c_f32_bf16 v32, v176, v14
    v_dot2c_f32_bf16 v33, v177, v14
    v_dot2c_f32_bf16 v34, v178, v14
    v_dot2c_f32_bf16 v35, v179, v14
    v_dot2c_f32_bf16 v36, v180, v14
    v_dot2c_f32_bf16 v37, v181, v14
    v_dot2c_f32_bf16 v38, v182, v14
    v_dot2c_f32_bf16 v39, v183, v14
    v_dot2c_f32_bf16 v32, v184, v15
    v_dot2c_f32_bf16 v33, v185, v15
    v_dot2c_f32_bf16 v34, v186, v15
    v_dot2c_f32_bf16 v35, v187, v15
    v_dot2c_f32_bf16 v36, v188, v15
    v_dot2c_f32_bf16 v37, v189, v15
    v_dot2c_f32_bf16 v38, v190, v15
    v_dot2c_f32_bf16 v39, v191, v15
    v_permlane32_swap_b32 v32, v36
    v_permlane32_swap_b32 v33, v37
    v_permlane32_swap_b32 v34, v38
    v_permlane32_swap_b32 v35, v39
    v_add_f32 v32, v32, v36
    v_add_f32 v33, v33, v37
    v_add_f32 v34, v34, v38
    v_add_f32 v35, v35, v39
    s_nop 0
    v_permlane16_swap_b32 v32, v34
    v_permlane16_swap_b32 v33, v35
    v_add_f32 v32, v32, v34
    v_add_f32 v33, v33, v35
    s_nop 0
    v_add_f32_dpp v32, v32, v32 row_ror:8 row_mask:0xf bank_mask:0xf
    v_add_f32_dpp v33, v33, v33 row_ror:8 row_mask:0xf bank_mask:0xf
    v_mov_b32 v34, s32
    v_mov_b32 v35, s33
    s_mov_b32 exec_lo, 0x00ff00ff
    s_mov_b32 exec_hi, 0x00ff00ff
    buffer_store_dwordx4 v[32:35], v21, s[36:39], s59 offen sc1
    s_mov_b64 exec, -1
    s_branch L_fin
L_S:
    s_load_dwordx2 s[32:33], s[26:27], 0
    s_load_dwordx2 s[24:25], s[26:27], 8
    s_mov_b32 s62, 0x00010001
    s_mov_b32 s36, s26
    s_mov_b32 s37, s27
    s_mov_b32 s38, 0x10000000
    s_mov_b32 s39, 0x20000
    s_mov_b32 s40, s6
    s_mov_b32 s41, s7
    s_mov_b32 s42, 0x2000000
    s_mov_b32 s43, 0x20000
    s_add_u32 s8, s35, 0
    s_and_b32 s8, s8, 7
    s_lshl_b32 s8, s8, 7
    s_add_u32 s9, s35, 1
    s_and_b32 s9, s9, 7
    s_lshl_b32 s9, s9, 7
    s_add_u32 s10, s35, 2
    s_and_b32 s10, s10, 7
    s_lshl_b32 s10, s10, 7
    s_add_u32 s11, s35, 3
    s_and_b32 s11, s11, 7
    s_lshl_b32 s11, s11, 7
    s_add_u32 s12, s35, 4
    s_and_b32 s12, s12, 7
    s_lshl_b32 s12, s12, 7
    s_add_u32 s13, s35, 5
    s_and_b32 s13, s13, 7
    s_lshl_b32 s13, s13, 7
    s_add_u32 s14, s35, 6
    s_and_b32 s14, s14, 7
    s_lshl_b32 s14, s14, 7
    s_add_u32 s15, s35, 7
    s_and_b32 s15, s15, 7
    s_lshl_b32 s15, s15, 7
    s_cmp_lg_u32 s28, 0
    s_cbranch_scc1 ep_38
    s_lshl_b32 s52, s3, 10
    s_add_u32 s53, s52, 65536
    buffer_load_dwordx4 v[32:35], v3, s[36:39], s53 offen sc1
    s_lshl_b32 s52, s3, 11
    s_lshl_b32 s53, s34, 10
    s_add_u32 s53, s53, 917504
    buffer_load_dwordx4 v[48:51], v3, s[36:39], s53 offen sc1
ep_38:
    v_bfe_u32 v9, v1, 4, 1
    v_lshlrev_b32 v9, 2, v9
    v_lshrrev_b32 v8, 5, v1
    v_or_b32 v9, v9, v8
    v_and_b32 v8, 7, v1
    v_xor_b32 v60, v9, v8
    v_lshrrev_b32 v4, 3, v1
    v_lshlrev_b32 v61, 10, v4
    v_lshl_add_u32 v61, v60, 4, v61
    v_lshlrev_b32 v4, 17, v4
    v_lshl_add_u32 v4, v60, 4, v4
    v_xor_b32 v5, 32, v4
s_lshl_b32 s52, s3, 10
    s_xor_b32 s53, s28, 4
    s_lshl_b32 s53, s53, 22
    s_add_u32 s52, s52, s53
    s_lshl_b32 s53, s31, 12
    v_mov_b32 v6, s31
    v_lshl_add_u32 v6, v6, 2, v2
    v_lshrrev_b32 v24, 5, v1
    v_bfe_u32 v25, v1, 2, 2
    v_lshl_add_u32 v25, v24, 2, v25
    v_lshlrev_b32 v25, 7, v25
    v_and_b32 v26, 1, v1
    v_lshl_add_u32 v25, v26, 3, v25
    s_lshl_b32 s54, s28, 14
    v_add_u32 v25, s54, v25
    v_bfe_u32 v26, v1, 4, 1
    v_lshlrev_b32 v26, 1, v26
    v_bfe_u32 v27, v1, 1, 1
    v_or_b32 v26, v26, v27
    v_bfe_u32 v27, v1, 3, 1
    v_lshl_or_b32 v27, v27, 2, v24
    v_xor_b32 v26, v26, v27
    v_xor_b32 v27, 0, v26
    v_lshl_add_u32 v28, v27, 4, v25
    v_xor_b32 v27, 4, v26
    v_lshl_add_u32 v29, v27, 4, v25
    v_xor_b32 v27, 2, v26
    v_lshl_add_u32 v30, v27, 4, v25
    v_xor_b32 v27, 6, v26
    v_lshl_add_u32 v31, v27, 4, v25
    v_and_b32 v24, 31, v1
    v_lshl_add_u32 v24, v24, 4, v2
    v_add_u32 v27, 131072, v3
    s_barrier
    s_cmp_ge_u32 s28, 4
    s_cbranch_scc1 L_A
    s_waitcnt lgkmcnt(0)
    s_mul_i32 s32, s32, 0x9E3779B1
    s_add_u32 s32, s32, 0x7F4A7C15
    s_mul_i32 s33, s33, 0x85EBCA6D
    s_add_u32 s33, s33, 0x2545F491
    s_xor_b32 s24, s24, 0x395b586c
    s_xor_b32 s25, s25, 0xc3e4962d
    s_lshl_b32 s53, s31, 10
    v_add_u32 v20, s53, v3
    v_add_u32 v21, 0x10000, v20
s_lshl_b32 s52, s3, 10
    s_lshl_b32 s53, s31, 20
    s_add_u32 s52, s52, s53
    s_add_u32 s52, s52, 16777216
    s_and_b32 s53, s31, 1
    s_lshl_b32 s53, s53, 5
    v_xor_b32 v4, s53, v4
    s_mov_b32 s98, 3200000
wf_39:
    ds_read_b128 v[8:11], v2 offset:64
    s_waitcnt lgkmcnt(0)
    v_and_b32 v8, v8, v9
    v_and_b32 v10, v10, v11
    v_and_b32 v8, v8, v10
    s_nop 0
    v_readfirstlane_b32 s101, v8
    s_nop 0
    s_cmp_lg_u32 s101, 0
    s_cbranch_scc1 wfd_40
    s_sleep 1
    s_sub_u32 s98, s98, 1
    s_cmp_lg_u32 s98, 0
    s_cbranch_scc1 wf_39
wfd_40:
    s_mov_b32 s99, 0
    s_waitcnt vmcnt(0)
    v_mov_b32 v32, 1
    v_mov_b32 v33, 2
    v_mov_b32 v34, 3
    v_mov_b32 v35, 4
    v_mov_b32 v36, 5
    v_mov_b32 v37, 6
    v_mov_b32 v38, 7
    v_mov_b32 v39, 8
    v_mov_b32 v40, 9
    v_mov_b32 v41, 10
    v_mov_b32 v42, 11
    v_mov_b32 v43, 12
    v_mov_b32 v44, 13
    v_mov_b32 v45, 14
    v_mov_b32 v46, 15
    v_mov_b32 v47, 16
    s_add_u32 s54, s52, 0
    s_add_u32 s54, s54, s8
    buffer_load_dwordx4 v[64:67], v4, s[40:43], s54 offen nt
    s_add_u32 s54, s52, 0
    s_add_u32 s54, s54, s9
    buffer_load_dwordx4 v[68:71], v4, s[40:43], s54 offen nt
    s_mov_b32 s98, 3200000
wf_41:
    ds_read_b128 v[8:11], v2 offset:224
    s_waitcnt lgkmcnt(0)
    v_and_b32 v8, v8, v9
    v_and_b32 v10, v10, v11
    v_and_b32 v8, v8, v10
    s_nop 0
    v_readfirstlane_b32 s101, v8
    s_nop 0
    s_cmp_lg_u32 s101, 0
    s_cbranch_scc1 wfd_42
    s_sub_u32 s98, s98, 1
    s_cmp_lg_u32 s98, 0
    s_cbranch_scc1 wf_41
wfd_42:
    s_add_u32 s54, s52, 0
    s_add_u32 s54, s54, s10
    buffer_load_dwordx4 v[72:75], v4, s[40:43], s54 offen nt
    s_add_u32 s54, s52, 0
    s_add_u32 s54, s54, s11
    buffer_load_dwordx4 v[76:79], v4, s[40:43], s54 offen nt
    s_add_u32 s54, s52, 0
    s_add_u32 s54, s54, s12
    buffer_load_dwordx4 v[80:83], v4, s[40:43], s54 offen nt
    s_add_u32 s54, s52, 0
    s_add_u32 s54, s54, s13
    buffer_load_dwordx4 v[84:87], v4, s[40:43], s54 offen nt
    s_add_u32 s54, s52, 0
    s_add_u32 s54, s54, s14
    buffer_load_dwordx4 v[88:91], v4, s[40:43], s54 offen nt
    s_add_u32 s54, s52, 0
    s_add_u32 s54, s54, s15
    buffer_load_dwordx4 v[92:95], v4, s[40:43], s54 offen nt
    s_add_u32 s54, s52, 4194304
    s_add_u32 s54, s54, s8
    buffer_load_dwordx4 v[96:99], v4, s[40:43], s54 offen nt
    s_cmp_lg_u32 s99, 0
    s_cbranch_scc1 sk_43
    ds_read_b128 v[8:11], v2 offset:80
    s_waitcnt vmcnt(8) lgkmcnt(0)
    v_and_b32 v8, v8, v9
    v_and_b32 v10, v10, v11
    v_and_b32 v8, v8, v10
    s_nop 0
    v_readfirstlane_b32 s99, v8
    s_nop 0
    s_mul_i32 s99, s99, 15
sk_43:
    s_cmp_lg_u32 s99, 9
    s_cbranch_scc1 nc_44
    s_call_b64 s[60:61], L_pva
nc_44:
    s_add_u32 s54, s52, 4194304
    s_add_u32 s54, s54, s9
    buffer_load_dwordx4 v[100:103], v4, s[40:43], s54 offen nt
    s_cmp_lg_u32 s99, 0
    s_cbranch_scc1 sk_45
    s_waitcnt vmcnt(8)
sk_45:
    s_add_u32 s54, s52, 4194304
    s_add_u32 s54, s54, s10
    buffer_load_dwordx4 v[104:107], v4, s[40:43], s54 offen nt
    s_cmp_lg_u32 s99, 0
    s_cbranch_scc1 sk_46
    ds_read_b128 v[8:11], v2 offset:80
    s_waitcnt vmcnt(8) lgkmcnt(0)
    v_and_b32 v8, v8, v9
    v_and_b32 v10, v10, v11
    v_and_b32 v8, v8, v10
    s_nop 0
    v_readfirstlane_b32 s99, v8
    s_nop 0
    s_mul_i32 s99, s99, 17
sk_46:
    s_cmp_lg_u32 s99, 11
    s_cbranch_scc1 nc_47
    s_call_b64 s[60:61], L_pva
nc_47:
    s_add_u32 s54, s52, 4194304
    s_add_u32 s54, s54, s11
    buffer_load_dwordx4 v[108:111], v4, s[40:43], s54 offen nt
    s_cmp_lg_u32 s99, 0
    s_cbranch_scc1 sk_48
    s_waitcnt vmcnt(8)
sk_48:
    s_add_u32 s54, s52, 4194304
    s_add_u32 s54, s54, s12
    buffer_load_dwordx4 v[112:115], v4, s[40:43], s54 offen nt
    s_cmp_lg_u32 s99, 0
    s_cbranch_scc1 sk_49
    ds_read_b128 v[8:11], v2 offset:80
    s_waitcnt vmcnt(8) lgkmcnt(0)
    v_and_b32 v8, v8, v9
    v_and_b32 v10, v10, v11
    v_and_b32 v8, v8, v10
    s_nop 0
    v_readfirstlane_b32 s99, v8
    s_nop 0
    s_mul_i32 s99, s99, 19
sk_49:
    s_cmp_lg_u32 s99, 13
    s_cbranch_scc1 nc_50
    s_call_b64 s[60:61], L_pva
nc_50:
    s_add_u32 s54, s52, 4194304
    s_add_u32 s54, s54, s13
    buffer_load_dwordx4 v[116:119], v4, s[40:43], s54 offen nt
    s_cmp_lg_u32 s99, 0
    s_cbranch_scc1 sk_51
    s_waitcnt vmcnt(8)
sk_51:
    s_add_u32 s54, s52, 4194304
    s_add_u32 s54, s54, s14
    buffer_load_dwordx4 v[120:123], v4, s[40:43], s54 offen nt
    s_cmp_lg_u32 s99, 0
    s_cbranch_scc1 sk_52
    ds_read_b128 v[8:11], v2 offset:80
    s_waitcnt vmcnt(8) lgkmcnt(0)
    v_and_b32 v8, v8, v9
    v_and_b32 v10, v10, v11
    v_and_b32 v8, v8, v10
    s_nop 0
    v_readfirstlane_b32 s99, v8
    s_nop 0
    s_mul_i32 s99, s99, 21
sk_52:
    s_cmp_lg_u32 s99, 15
    s_cbranch_scc1 nc_53
    s_call_b64 s[60:61], L_pva
nc_53:
    s_add_u32 s54, s52, 4194304
    s_add_u32 s54, s54, s15
    buffer_load_dwordx4 v[124:127], v4, s[40:43], s54 offen nt
    s_cmp_lg_u32 s28, 0
    s_cbranch_scc1 hs_54
    v_mov_b32 v12, s32
    v_mov_b32 v13, s33
    v_mov_b32 v14, s32
    v_mov_b32 v15, s33
    s_lshl_b32 s57, s3, 9
    s_add_u32 s57, s57, 720896
    s_mov_b64 exec, 0xff
    buffer_store_dwordx4 v[12:15], v3, s[36:39], s57 offen sc1
    s_mov_b64 exec, -1
hs_54:
    s_cmp_lg_u32 s99, 0
    s_cbranch_scc1 sk_55
    s_waitcnt vmcnt(8)
sk_55:
    s_add_u32 s54, s52, 8388608
    s_add_u32 s54, s54, s8
    buffer_load_dwordx4 v[128:131], v4, s[40:43], s54 offen nt
    s_cmp_lg_u32 s99, 0
    s_cbranch_scc1 sk_56
    ds_read_b128 v[8:11], v2 offset:80
    s_waitcnt vmcnt(8) lgkmcnt(0)
    v_and_b32 v8, v8, v9
    v_and_b32 v10, v10, v11
    v_and_b32 v8, v8, v10
    s_nop 0
    v_readfirstlane_b32 s99, v8
    s_nop 0
    s_mul_i32 s99, s99, 23
sk_56:
    s_cmp_lg_u32 s99, 17
    s_cbranch_scc1 nc_57
    s_call_b64 s[60:61], L_pva
nc_57:
    s_add_u32 s54, s52, 8388608
    s_add_u32 s54, s54, s9
    buffer_load_dwordx4 v[132:135], v4, s[40:43], s54 offen nt
    s_cmp_lg_u32 s99, 0
    s_cbranch_scc1 sk_58
    s_waitcnt vmcnt(8)
sk_58:
    s_add_u32 s54, s52, 12582912
    s_add_u32 s54, s54, s8
    buffer_load_dwordx4 v[136:139], v4, s[40:43], s54 offen nt
    s_cmp_lg_u32 s99, 0
    s_cbranch_scc1 sk_59
    ds_read_b128 v[8:11], v2 offset:80
    s_waitcnt vmcnt(8) lgkmcnt(0)
    v_and_b32 v8, v8, v9
    v_and_b32 v10, v10, v11
    v_and_b32 v8, v8, v10
    s_nop 0
    v_readfirstlane_b32 s99, v8
    s_nop 0
    s_mul_i32 s99, s99, 25
sk_59:
    s_cmp_lg_u32 s99, 19
    s_cbranch_scc1 nc_60
    s_call_b64 s[60:61], L_pva
nc_60:
    s_add_u32 s54, s52, 12582912
    s_add_u32 s54, s54, s9
    buffer_load_dwordx4 v[140:143], v4, s[40:43], s54 offen nt
    s_cmp_lg_u32 s99, 0
    s_cbranch_scc1 sk_61
    s_waitcnt vmcnt(8)
sk_61:
    s_add_u32 s54, s52, 8388608
    s_add_u32 s54, s54, s10
    buffer_load_dwordx4 v[144:147], v4, s[40:43], s54 offen nt
    s_cmp_lg_u32 s99, 0
    s_cbranch_scc1 sk_62
    ds_read_b128 v[8:11], v2 offset:80
    s_waitcnt vmcnt(8) lgkmcnt(0)
    v_and_b32 v8, v8, v9
    v_and_b32 v10, v10, v11
    v_and_b32 v8, v8, v10
    s_nop 0
    v_readfirstlane_b32 s99, v8
    s_nop 0
    s_mul_i32 s99, s99, 27
sk_62:
    s_cmp_lg_u32 s99, 21
    s_cbranch_scc1 nc_63
    s_call_b64 s[60:61], L_pva
nc_63:
    s_add_u32 s54, s52, 8388608
    s_add_u32 s54, s54, s11
    buffer_load_dwordx4 v[148:151], v4, s[40:43], s54 offen nt
    s_cmp_lg_u32 s99, 0
    s_cbranch_scc1 sk_64
    s_waitcnt vmcnt(8)
sk_64:
    s_add_u32 s54, s52, 12582912
    s_add_u32 s54, s54, s10
    buffer_load_dwordx4 v[152:155], v4, s[40:43], s54 offen nt
    s_cmp_lg_u32 s99, 0
    s_cbranch_scc1 sk_65
    ds_read_b128 v[8:11], v2 offset:80
    s_waitcnt vmcnt(8) lgkmcnt(0)
    v_and_b32 v8, v8, v9
    v_and_b32 v10, v10, v11
    v_and_b32 v8, v8, v10
    s_nop 0
    v_readfirstlane_b32 s99, v8
    s_nop 0
    s_mul_i32 s99, s99, 29
sk_65:
    s_cmp_lg_u32 s99, 23
    s_cbranch_scc1 nc_66
    s_call_b64 s[60:61], L_pva8
nc_66:
    s_add_u32 s54, s52, 12582912
    s_add_u32 s54, s54, s11
    buffer_load_dwordx4 v[156:159], v4, s[40:43], s54 offen nt
    s_cmp_lg_u32 s99, 0
    s_cbranch_scc1 sk_67
    s_waitcnt vmcnt(8)
sk_67:
    s_add_u32 s54, s52, 8388608
    s_add_u32 s54, s54, s12
    buffer_load_dwordx4 v[160:163], v4, s[40:43], s54 offen nt
    s_cmp_lg_u32 s99, 0
    s_cbranch_scc1 sk_68
    ds_read_b128 v[8:11], v2 offset:80
    s_waitcnt vmcnt(8) lgkmcnt(0)
    v_and_b32 v8, v8, v9
    v_and_b32 v10, v10, v11
    v_and_b32 v8, v8, v10
    s_nop 0
    v_readfirstlane_b32 s99, v8
    s_nop 0
    s_mul_i32 s99, s99, 31
sk_68:
    s_cmp_lg_u32 s99, 25
    s_cbranch_scc1 nc_69
    s_call_b64 s[60:61], L_pva8
nc_69:
    s_add_u32 s54, s52, 8388608
    s_add_u32 s54, s54, s13
    buffer_load_dwordx4 v[164:167], v4, s[40:43], s54 offen nt
    s_cmp_lg_u32 s99, 0
    s_cbranch_scc1 sk_70
    s_waitcnt vmcnt(8)
sk_70:
    s_add_u32 s54, s52, 12582912
    s_add_u32 s54, s54, s12
    buffer_load_dwordx4 v[168:171], v4, s[40:43], s54 offen nt
    s_cmp_lg_u32 s99, 0
    s_cbranch_scc1 sk_71
    ds_read_b128 v[8:11], v2 offset:80
    s_waitcnt vmcnt(8) lgkmcnt(0)
    v_and_b32 v8, v8, v9
    v_and_b32 v10, v10, v11
    v_and_b32 v8, v8, v10
    s_nop 0
    v_readfirstlane_b32 s99, v8
    s_nop 0
    s_mul_i32 s99, s99, 32
sk_71:
    s_cmp_lg_u32 s99, 27
    s_cbranch_scc1 nc_72
    s_call_b64 s[60:61], L_pva8
nc_72:
    s_add_u32 s54, s52, 12582912
    s_add_u32 s54, s54, s13
    buffer_load_dwordx4 v[172:175], v4, s[40:43], s54 offen nt
    s_cmp_lg_u32 s99, 0
    s_cbranch_scc1 sk_73
    s_waitcnt vmcnt(8)
sk_73:
    s_add_u32 s54, s52, 8388608
    s_add_u32 s54, s54, s14
    buffer_load_dwordx4 v[176:179], v4, s[40:43], s54 offen nt
    s_cmp_lg_u32 s99, 0
    s_cbranch_scc1 sk_74
    ds_read_b128 v[8:11], v2 offset:80
    s_waitcnt vmcnt(8) lgkmcnt(0)
    v_and_b32 v8, v8, v9
    v_and_b32 v10, v10, v11
    v_and_b32 v8, v8, v10
    s_nop 0
    v_readfirstlane_b32 s99, v8
    s_nop 0
    s_mul_i32 s99, s99, 32
sk_74:
    s_cmp_lg_u32 s99, 29
    s_cbranch_scc1 nc_75
    s_call_b64 s[60:61], L_pva8
nc_75:
    s_add_u32 s54, s52, 8388608
    s_add_u32 s54, s54, s15
    buffer_load_dwordx4 v[180:183], v4, s[40:43], s54 offen nt
    s_cmp_lg_u32 s99, 0
    s_cbranch_scc1 sk_76
    s_waitcnt vmcnt(8)
sk_76:
    s_add_u32 s54, s52, 12582912
    s_add_u32 s54, s54, s14
    buffer_load_dwordx4 v[184:187], v4, s[40:43], s54 offen nt
    s_cmp_lg_u32 s99, 0
    s_cbranch_scc1 sk_77
    ds_read_b128 v[8:11], v2 offset:80
    s_waitcnt vmcnt(8) lgkmcnt(0)
    v_and_b32 v8, v8, v9
    v_and_b32 v10, v10, v11
    v_and_b32 v8, v8, v10
    s_nop 0
    v_readfirstlane_b32 s99, v8
    s_nop 0
    s_mul_i32 s99, s99, 32
sk_77:
    s_cmp_lg_u32 s99, 31
    s_cbranch_scc1 nc_78
    s_call_b64 s[60:61], L_pva16
nc_78:
    s_add_u32 s54, s52, 12582912
    s_add_u32 s54, s54, s15
    buffer_load_dwordx4 v[188:191], v4, s[40:43], s54 offen nt
    s_cmp_ge_u32 s99, 100
    s_cbranch_scc1 nc_79
    s_mov_b32 s98, 3200000
wf_80:
    ds_read_b128 v[12:15], v2 offset:32
    s_waitcnt lgkmcnt(0)
    v_and_b32 v12, v12, v13
    v_and_b32 v14, v14, v15
    v_and_b32 v12, v12, v14
    s_nop 0
    v_readfirstlane_b32 s101, v12
    s_nop 0
    s_cmp_lg_u32 s101, 0
    s_cbranch_scc1 wfd_81
    s_sleep 1
    s_sub_u32 s98, s98, 1
    s_cmp_lg_u32 s98, 0
    s_cbranch_scc1 wf_80
wfd_81:
    s_waitcnt vmcnt(16)
    s_call_b64 s[60:61], L_pva16
nc_79:
    s_cmp_eq_u32 s99, 116
    s_cbranch_scc1 L_bw8
    s_cmp_eq_u32 s99, 108
    s_cbranch_scc1 L_bw4
    s_waitcnt vmcnt(30)
    ds_write_b128 v20, v[64:67] offset:0
    ds_write_b128 v20, v[68:71] offset:16384
    ds_write_b32 v6, v32 offset:160
    s_waitcnt vmcnt(28)
    ds_write_b128 v20, v[72:75] offset:32768
    ds_write_b128 v20, v[76:79] offset:49152
    ds_write_b32 v6, v33 offset:160
    s_waitcnt vmcnt(26)
    ds_write_b128 v21, v[80:83] offset:0
    ds_write_b128 v21, v[84:87] offset:16384
    ds_write_b32 v6, v34 offset:160
    s_waitcnt vmcnt(24)
    ds_write_b128 v21, v[88:91] offset:32768
    ds_write_b128 v21, v[92:95] offset:49152
    ds_write_b32 v6, v35 offset:160
L_bw4:
    s_waitcnt vmcnt(22)
    ds_write_b128 v20, v[96:99] offset:4096
    ds_write_b128 v20, v[100:103] offset:20480
    ds_write_b32 v6, v36 offset:160
    s_waitcnt vmcnt(20)
    ds_write_b128 v20, v[104:107] offset:36864
    ds_write_b128 v20, v[108:111] offset:53248
    ds_write_b32 v6, v37 offset:160
    s_waitcnt vmcnt(18)
    ds_write_b128 v21, v[112:115] offset:4096
    ds_write_b128 v21, v[116:119] offset:20480
    ds_write_b32 v6, v38 offset:160
    s_waitcnt vmcnt(16)
    ds_write_b128 v21, v[120:123] offset:36864
    ds_write_b128 v21, v[124:127] offset:53248
    ds_write_b32 v6, v39 offset:160
L_bw8:
    s_waitcnt vmcnt(14)
    ds_write_b128 v20, v[128:131] offset:8192
    ds_write_b128 v20, v[132:135] offset:24576
    ds_write_b32 v6, v40 offset:160
    s_waitcnt vmcnt(12)
    ds_write_b128 v20, v[136:139] offset:12288
    ds_write_b128 v20, v[140:143] offset:28672
    ds_write_b32 v6, v41 offset:160
    s_waitcnt vmcnt(10)
    ds_write_b128 v20, v[144:147] offset:40960
    ds_write_b128 v20, v[148:151] offset:57344
    ds_write_b32 v6, v42 offset:160
    s_waitcnt vmcnt(8)
    ds_write_b128 v20, v[152:155] offset:45056
    ds_write_b128 v20, v[156:159] offset:61440
    ds_write_b32 v6, v43 offset:160
    s_waitcnt vmcnt(6)
    ds_write_b128 v21, v[160:163] offset:8192
    ds_write_b128 v21, v[164:167] offset:24576
    ds_write_b32 v6, v44 offset:160
    s_waitcnt vmcnt(4)
    ds_write_b128 v21, v[168:171] offset:12288
    ds_write_b128 v21, v[172:175] offset:28672
    ds_write_b32 v6, v45 offset:160
    s_waitcnt vmcnt(2)
    ds_write_b128 v21, v[176:179] offset:40960
    ds_write_b128 v21, v[180:183] offset:57344
    ds_write_b32 v6, v46 offset:160
    s_waitcnt vmcnt(0)
    ds_write_b128 v21, v[184:187] offset:45056
    ds_write_b128 v21, v[188:191] offset:61440
    ds_write_b32 v6, v47 offset:160
    ds_read_b128 v[8:11], v24 offset:256
    s_mov_b32 s98, 3200000
h1_82:
    ds_read_b128 v[12:15], v2 offset:160
    s_waitcnt lgkmcnt(0)
    v_min3_u32 v12, v12, v13, v14
    v_min_u32 v12, v12, v15
    s_nop 0
    v_readfirstlane_b32 s101, v12
    s_nop 0
    s_cmp_ge_u32 s101, 8
    s_cbranch_scc1 h1d_83
    s_sub_u32 s98, s98, 1
    s_cmp_lg_u32 s98, 0
    s_cbranch_scc1 h1_82
h1d_83:
    v_max3_f32 v8, v8, v9, v10
    v_max_f32 v8, v8, v11
    ds_read_b64_tr_b16 v[192:193], v28 offset:0
    ds_read_b64_tr_b16 v[194:195], v30 offset:1024
    ds_read_b64_tr_b16 v[196:197], v29 offset:0
    ds_read_b64_tr_b16 v[198:199], v31 offset:1024
    ds_read_b64_tr_b16 v[200:201], v28 offset:2048
    ds_read_b64_tr_b16 v[202:203], v30 offset:3072
    ds_read_b64_tr_b16 v[204:205], v29 offset:2048
    ds_read_b64_tr_b16 v[206:207], v31 offset:3072
    ds_read_b64_tr_b16 v[208:209], v28 offset:4096
    ds_read_b64_tr_b16 v[210:211], v30 offset:5120
    ds_read_b64_tr_b16 v[212:213], v29 offset:4096
    ds_read_b64_tr_b16 v[214:215], v31 offset:5120
    ds_read_b64_tr_b16 v[216:217], v28 offset:6144
    ds_read_b64_tr_b16 v[218:219], v30 offset:7168
    ds_read_b64_tr_b16 v[220:221], v29 offset:6144
    ds_read_b64_tr_b16 v[222:223], v31 offset:7168
    s_barrier
    s_branch L_pv2
L_pva:
    ds_read_b64_tr_b16 v[192:193], v28 offset:0
    ds_read_b64_tr_b16 v[194:195], v30 offset:1024
    ds_read_b64_tr_b16 v[196:197], v29 offset:0
    ds_read_b64_tr_b16 v[198:199], v31 offset:1024
    ds_read_b64_tr_b16 v[200:201], v28 offset:2048
    ds_read_b64_tr_b16 v[202:203], v30 offset:3072
    ds_read_b64_tr_b16 v[204:205], v29 offset:2048
    ds_read_b64_tr_b16 v[206:207], v31 offset:3072
    ds_read_b64_tr_b16 v[208:209], v28 offset:4096
    ds_read_b64_tr_b16 v[210:211], v30 offset:5120
    ds_read_b64_tr_b16 v[212:213], v29 offset:4096
    ds_read_b64_tr_b16 v[214:215], v31 offset:5120
    ds_read_b64_tr_b16 v[216:217], v28 offset:6144
    ds_read_b64_tr_b16 v[218:219], v30 offset:7168
    ds_read_b64_tr_b16 v[220:221], v29 offset:6144
    ds_read_b64_tr_b16 v[222:223], v31 offset:7168
    s_waitcnt lgkmcnt(0)
    s_barrier
    ds_read_b128 v[48:51], v27 offset:0
    ds_read_b128 v[52:55], v27 offset:1024
    ds_read_b128 v[56:59], v27 offset:2048
    ds_read_b128 v[60:63], v27 offset:3072
    s_waitcnt lgkmcnt(3)
    v_mfma_f32_32x32x16_bf16 v[224:239], v[192:195], v[48:51], 0
    ds_read_b64_tr_b16 v[192:193], v28 offset:8192
    ds_read_b64_tr_b16 v[194:195], v30 offset:9216
    v_mfma_f32_32x32x16_bf16 v[240:255], v[196:199], v[48:51], 0
    ds_read_b64_tr_b16 v[196:197], v29 offset:8192
    ds_read_b64_tr_b16 v[198:199], v31 offset:9216
    ds_read_b128 v[48:51], v27 offset:4096
    s_waitcnt lgkmcnt(7)
    v_mfma_f32_32x32x16_bf16 v[224:239], v[200:203], v[52:55], v[224:239]
    ds_read_b64_tr_b16 v[200:201], v28 offset:10240
    ds_read_b64_tr_b16 v[202:203], v30 offset:11264
    v_mfma_f32_32x32x16_bf16 v[240:255], v[204:207], v[52:55], v[240:255]
    ds_read_b64_tr_b16 v[204:205], v29 offset:10240
    ds_read_b64_tr_b16 v[206:207], v31 offset:11264
    ds_read_b128 v[52:55], v27 offset:5120
    s_waitcnt lgkmcnt(11)
    v_mfma_f32_32x32x16_bf16 v[224:239], v[208:211], v[56:59], v[224:239]
    ds_read_b64_tr_b16 v[208:209], v28 offset:12288
    ds_read_b64_tr_b16 v[210:211], v30 offset:13312
    v_mfma_f32_32x32x16_bf16 v[240:255], v[212:215], v[56:59], v[240:255]
    ds_read_b64_tr_b16 v[212:213], v29 offset:12288
    ds_read_b64_tr_b16 v[214:215], v31 offset:13312
    ds_read_b128 v[56:59], v27 offset:6144
    s_waitcnt lgkmcnt(15)
    v_mfma_f32_32x32x16_bf16 v[224:239], v[216:219], v[60:63], v[224:239]
    ds_read_b64_tr_b16 v[216:217], v28 offset:14336
    ds_read_b64_tr_b16 v[218:219], v30 offset:15360
    v_mfma_f32_32x32x16_bf16 v[240:255], v[220:223], v[60:63], v[240:255]
    ds_read_b64_tr_b16 v[220:221], v29 offset:14336
    ds_read_b64_tr_b16 v[222:223], v31 offset:15360
    ds_read_b128 v[60:63], v27 offset:7168
    s_waitcnt lgkmcnt(15)
    v_mfma_f32_32x32x16_bf16 v[224:239], v[192:195], v[48:51], v[224:239]
    v_mfma_f32_32x32x16_bf16 v[240:255], v[196:199], v[48:51], v[240:255]
    s_waitcnt lgkmcnt(10)
    v_mfma_f32_32x32x16_bf16 v[224:239], v[200:203], v[52:55], v[224:239]
    v_mfma_f32_32x32x16_bf16 v[240:255], v[204:207], v[52:55], v[240:255]
    s_waitcnt lgkmcnt(5)
    v_mfma_f32_32x32x16_bf16 v[224:239], v[208:211], v[56:59], v[224:239]
    v_mfma_f32_32x32x16_bf16 v[240:255], v[212:215], v[56:59], v[240:255]
    s_waitcnt lgkmcnt(0)
    s_barrier
    v_mfma_f32_32x32x16_bf16 v[224:239], v[216:219], v[60:63], v[224:239]
    v_mfma_f32_32x32x16_bf16 v[240:255], v[220:223], v[60:63], v[240:255]
    s_mov_b32 s99, 100
    s_setpc_b64 s[60:61]
L_pva8:
    ds_read_b64_tr_b16 v[192:193], v28 offset:0
    ds_read_b64_tr_b16 v[194:195], v30 offset:1024
    ds_read_b64_tr_b16 v[196:197], v29 offset:0
    ds_read_b64_tr_b16 v[198:199], v31 offset:1024
    ds_read_b64_tr_b16 v[200:201], v28 offset:2048
    ds_read_b64_tr_b16 v[202:203], v30 offset:3072
    ds_read_b64_tr_b16 v[204:205], v29 offset:2048
    ds_read_b64_tr_b16 v[206:207], v31 offset:3072
    ds_read_b64_tr_b16 v[208:209], v28 offset:4096
    ds_read_b64_tr_b16 v[210:211], v30 offset:5120
    ds_read_b64_tr_b16 v[212:213], v29 offset:4096
    ds_read_b64_tr_b16 v[214:215], v31 offset:5120
    ds_read_b64_tr_b16 v[216:217], v28 offset:6144
    ds_read_b64_tr_b16 v[218:219], v30 offset:7168
    ds_read_b64_tr_b16 v[220:221], v29 offset:6144
    ds_read_b64_tr_b16 v[222:223], v31 offset:7168
    s_waitcnt lgkmcnt(0)
    s_barrier
    ds_read_b128 v[48:51], v27 offset:0
    ds_read_b128 v[52:55], v27 offset:1024
    ds_read_b128 v[56:59], v27 offset:2048
    ds_read_b128 v[60:63], v27 offset:3072
    s_waitcnt lgkmcnt(3)
    v_mfma_f32_32x32x16_bf16 v[224:239], v[192:195], v[48:51], 0
    ds_read_b64_tr_b16 v[192:193], v28 offset:8192
    ds_read_b64_tr_b16 v[194:195], v30 offset:9216
    v_mfma_f32_32x32x16_bf16 v[240:255], v[196:199], v[48:51], 0
    ds_read_b64_tr_b16 v[196:197], v29 offset:8192
    ds_read_b64_tr_b16 v[198:199], v31 offset:9216
    ds_read_b128 v[48:51], v27 offset:4096
    s_waitcnt lgkmcnt(7)
    v_mfma_f32_32x32x16_bf16 v[224:239], v[200:203], v[52:55], v[224:239]
    ds_read_b64_tr_b16 v[200:201], v28 offset:10240
    ds_read_b64_tr_b16 v[202:203], v30 offset:11264
    v_mfma_f32_32x32x16_bf16 v[240:255], v[204:207], v[52:55], v[240:255]
    ds_read_b64_tr_b16 v[204:205], v29 offset:10240
    ds_read_b64_tr_b16 v[206:207], v31 offset:11264
    ds_read_b128 v[52:55], v27 offset:5120
    s_waitcnt lgkmcnt(11)
    v_mfma_f32_32x32x16_bf16 v[224:239], v[208:211], v[56:59], v[224:239]
    ds_read_b64_tr_b16 v[208:209], v28 offset:12288
    ds_read_b64_tr_b16 v[210:211], v30 offset:13312
    v_mfma_f32_32x32x16_bf16 v[240:255], v[212:215], v[56:59], v[240:255]
    ds_read_b64_tr_b16 v[212:213], v29 offset:12288
    ds_read_b64_tr_b16 v[214:215], v31 offset:13312
    ds_read_b128 v[56:59], v27 offset:6144
    s_waitcnt lgkmcnt(15)
    v_mfma_f32_32x32x16_bf16 v[224:239], v[216:219], v[60:63], v[224:239]
    ds_read_b64_tr_b16 v[216:217], v28 offset:14336
    ds_read_b64_tr_b16 v[218:219], v30 offset:15360
    v_mfma_f32_32x32x16_bf16 v[240:255], v[220:223], v[60:63], v[240:255]
    ds_read_b64_tr_b16 v[220:221], v29 offset:14336
    ds_read_b64_tr_b16 v[222:223], v31 offset:15360
    ds_read_b128 v[60:63], v27 offset:7168
    s_waitcnt lgkmcnt(15)
    v_mfma_f32_32x32x16_bf16 v[224:239], v[192:195], v[48:51], v[224:239]
    ds_write_b128 v20, v[64:67] offset:0
    v_mfma_f32_32x32x16_bf16 v[240:255], v[196:199], v[48:51], v[240:255]
    ds_write_b128 v20, v[68:71] offset:16384
    ds_write_b32 v6, v32 offset:160
    s_waitcnt lgkmcnt(13)
    v_mfma_f32_32x32x16_bf16 v[224:239], v[200:203], v[52:55], v[224:239]
    ds_write_b128 v20, v[72:75] offset:32768
    v_mfma_f32_32x32x16_bf16 v[240:255], v[204:207], v[52:55], v[240:255]
    ds_write_b128 v20, v[76:79] offset:49152
    ds_write_b32 v6, v33 offset:160
    s_waitcnt lgkmcnt(11)
    v_mfma_f32_32x32x16_bf16 v[224:239], v[208:211], v[56:59], v[224:239]
    ds_write_b128 v21, v[80:83] offset:0
    v_mfma_f32_32x32x16_bf16 v[240:255], v[212:215], v[56:59], v[240:255]
    ds_write_b128 v21, v[84:87] offset:16384
    ds_write_b32 v6, v34 offset:160
    s_waitcnt lgkmcnt(9)
    s_barrier
    v_mfma_f32_32x32x16_bf16 v[224:239], v[216:219], v[60:63], v[224:239]
    ds_write_b128 v21, v[88:91] offset:32768
    v_mfma_f32_32x32x16_bf16 v[240:255], v[220:223], v[60:63], v[240:255]
    ds_write_b128 v21, v[92:95] offset:49152
    ds_write_b32 v6, v35 offset:160
    s_mov_b32 s99, 108
    s_setpc_b64 s[60:61]
L_pva16:
    ds_read_b64_tr_b16 v[192:193], v28 offset:0
    ds_read_b64_tr_b16 v[194:195], v30 offset:1024
    ds_read_b64_tr_b16 v[196:197], v29 offset:0
    ds_read_b64_tr_b16 v[198:199], v31 offset:1024
    ds_read_b64_tr_b16 v[200:201], v28 offset:2048
    ds_read_b64_tr_b16 v[202:203], v30 offset:3072
    ds_read_b64_tr_b16 v[204:205], v29 offset:2048
    ds_read_b64_tr_b16 v[206:207], v31 offset:3072
    ds_read_b64_tr_b16 v[208:209], v28 offset:4096
    ds_read_b64_tr_b16 v[210:211], v30 offset:5120
    ds_read_b64_tr_b16 v[212:213], v29 offset:4096
    ds_read_b64_tr_b16 v[214:215], v31 offset:5120
    ds_read_b64_tr_b16 v[216:217], v28 offset:6144
    ds_read_b64_tr_b16 v[218:219], v30 offset:7168
    ds_read_b64_tr_b16 v[220:221], v29 offset:6144
    ds_read_b64_tr_b16 v[222:223], v31 offset:7168
    s_waitcnt lgkmcnt(0)
    s_barrier
    ds_read_b128 v[48:51], v27 offset:0
    ds_read_b128 v[52:55], v27 offset:1024
    ds_read_b128 v[56:59], v27 offset:2048
    ds_read_b128 v[60:63], v27 offset:3072
    s_waitcnt lgkmcnt(3)
    v_mfma_f32_32x32x16_bf16 v[224:239], v[192:195], v[48:51], 0
    ds_read_b64_tr_b16 v[192:193], v28 offset:8192
    ds_read_b64_tr_b16 v[194:195], v30 offset:9216
    v_mfma_f32_32x32x16_bf16 v[240:255], v[196:199], v[48:51], 0
    ds_read_b64_tr_b16 v[196:197], v29 offset:8192
    ds_read_b64_tr_b16 v[198:199], v31 offset:9216
    ds_read_b128 v[48:51], v27 offset:4096
    s_waitcnt lgkmcnt(7)
    v_mfma_f32_32x32x16_bf16 v[224:239], v[200:203], v[52:55], v[224:239]
    ds_read_b64_tr_b16 v[200:201], v28 offset:10240
    ds_read_b64_tr_b16 v[202:203], v30 offset:11264
    v_mfma_f32_32x32x16_bf16 v[240:255], v[204:207], v[52:55], v[240:255]
    ds_read_b64_tr_b16 v[204:205], v29 offset:10240
    ds_read_b64_tr_b16 v[206:207], v31 offset:11264
    ds_read_b128 v[52:55], v27 offset:5120
    s_waitcnt lgkmcnt(11)
    v_mfma_f32_32x32x16_bf16 v[224:239], v[208:211], v[56:59], v[224:239]
    ds_read_b64_tr_b16 v[208:209], v28 offset:12288
    ds_read_b64_tr_b16 v[210:211], v30 offset:13312
    v_mfma_f32_32x32x16_bf16 v[240:255], v[212:215], v[56:59], v[240:255]
    ds_read_b64_tr_b16 v[212:213], v29 offset:12288
    ds_read_b64_tr_b16 v[214:215], v31 offset:13312
    ds_read_b128 v[56:59], v27 offset:6144
    s_waitcnt lgkmcnt(15)
    v_mfma_f32_32x32x16_bf16 v[224:239], v[216:219], v[60:63], v[224:239]
    ds_read_b64_tr_b16 v[216:217], v28 offset:14336
    ds_read_b64_tr_b16 v[218:219], v30 offset:15360
    v_mfma_f32_32x32x16_bf16 v[240:255], v[220:223], v[60:63], v[240:255]
    ds_read_b64_tr_b16 v[220:221], v29 offset:14336
    ds_read_b64_tr_b16 v[222:223], v31 offset:15360
    ds_read_b128 v[60:63], v27 offset:7168
    s_waitcnt lgkmcnt(15)
    v_mfma_f32_32x32x16_bf16 v[224:239], v[192:195], v[48:51], v[224:239]
    ds_write_b128 v20, v[64:67] offset:0
    ds_write_b128 v20, v[68:71] offset:16384
    v_mfma_f32_32x32x16_bf16 v[240:255], v[196:199], v[48:51], v[240:255]
    ds_write_b128 v20, v[72:75] offset:32768
    ds_write_b128 v20, v[76:79] offset:49152
    ds_write_b32 v6, v33 offset:160
    s_waitcnt lgkmcnt(15)
    v_mfma_f32_32x32x16_bf16 v[224:239], v[200:203], v[52:55], v[224:239]
    ds_write_b128 v21, v[80:83] offset:0
    ds_write_b128 v21, v[84:87] offset:16384
    v_mfma_f32_32x32x16_bf16 v[240:255], v[204:207], v[52:55], v[240:255]
    ds_write_b128 v21, v[88:91] offset:32768
    ds_write_b128 v21, v[92:95] offset:49152
    ds_write_b32 v6, v35 offset:160
    s_waitcnt lgkmcnt(15)
    v_mfma_f32_32x32x16_bf16 v[224:239], v[208:211], v[56:59], v[224:239]
    ds_write_b128 v20, v[96:99] offset:4096
    ds_write_b128 v20, v[100:103] offset:20480
    v_mfma_f32_32x32x16_bf16 v[240:255], v[212:215], v[56:59], v[240:255]
    ds_write_b128 v20, v[104:107] offset:36864
    ds_write_b128 v20, v[108:111] offset:53248
    ds_write_b32 v6, v37 offset:160
    s_waitcnt lgkmcnt(15)
    s_barrier
    v_mfma_f32_32x32x16_bf16 v[224:239], v[216:219], v[60:63], v[224:239]
    ds_write_b128 v21, v[112:115] offset:4096
    ds_write_b128 v21, v[116:119] offset:20480
    v_mfma_f32_32x32x16_bf16 v[240:255], v[220:223], v[60:63], v[240:255]
    ds_write_b128 v21, v[120:123] offset:36864
    ds_write_b128 v21, v[124:127] offset:53248
    ds_write_b32 v6, v39 offset:160
    s_mov_b32 s99, 116
    s_setpc_b64 s[60:61]
L_A:
    v_and_b32 v10, 31, v1
    v_bfe_u32 v7, v10, 1, 1
    v_lshlrev_b32 v7, 2, v7
    v_bfe_u32 v8, v10, 2, 2
    v_or_b32 v7, v7, v8
    v_lshrrev_b32 v8, 5, v1
    v_xor_b32 v7, v7, v8
    v_lshlrev_b32 v10, 7, v10
    v_lshl_add_u32 v10, v7, 4, v10
    v_xor_b32 v7, 0, v10
    v_add_u32 v12, 114688, v7
    v_add_u32 v16, s53, v7
    v_add_u32 v20, 0x10000, v16
    v_xor_b32 v7, 32, v10
    v_add_u32 v13, 114688, v7
    v_add_u32 v17, s53, v7
    v_add_u32 v21, 0x10000, v17
    v_xor_b32 v7, 64, v10
    v_add_u32 v14, 114688, v7
    v_add_u32 v18, s53, v7
    v_add_u32 v22, 0x10000, v18
    v_xor_b32 v7, 96, v10
    v_add_u32 v15, 114688, v7
    v_add_u32 v19, s53, v7
    v_add_u32 v23, 0x10000, v19
    s_lshl_b32 s54, s31, 2
    v_add_u32 v25, s54, v24
    s_lshl_b32 s54, s31, 11
    v_add_u32 v26, s54, v27
    s_and_b32 s58, s31, 1
    s_lshl_b32 s58, s58, 1
    v_xor_b32 v60, s58, v60
    s_lshl_b32 s58, s58, 4
    v_xor_b32 v61, s58, v61
    s_lshl_b32 s59, s31, 13
    s_add_u32 s59, s59, 589824
    s_lshl_b32 s58, s31, 10
    s_add_u32 s58, s58, 114688
    v_add_u32 v62, s58, v3
    s_add_u32 s54, s53, 114688
    v_add_u32 v63, s54, v3
    v_mov_b32 v7, 1
    s_waitcnt lgkmcnt(0)
    s_mul_i32 s32, s32, 0x9E3779B1
    s_add_u32 s32, s32, 0x7F4A7C15
    s_mul_i32 s33, s33, 0x85EBCA6D
    s_add_u32 s33, s33, 0x2545F491
    s_xor_b32 s24, s24, 0x395b586c
    s_xor_b32 s25, s25, 0xc3e4962d
    s_add_u32 s54, s52, 0
    s_add_u32 s54, s54, s15
    s_add_u32 m0, s53, 114688
    s_nop 0
    buffer_load_dwordx4 v4, s[40:43], s54 offen nt lds
    s_waitcnt vmcnt(0)
    s_add_u32 s54, s52, 1048576
    s_add_u32 s54, s54, s15
    s_add_u32 m0, s53, 115712
    s_nop 0
    buffer_load_dwordx4 v5, s[40:43], s54 offen nt lds
    s_add_u32 s54, s52, 2097152
    s_add_u32 s54, s54, s15
    s_add_u32 m0, s53, 116736
    s_nop 0
    buffer_load_dwordx4 v4, s[40:43], s54 offen nt lds
    s_add_u32 s54, s52, 3145728
    s_add_u32 s54, s54, s15
    s_add_u32 m0, s53, 117760
    s_nop 0
    buffer_load_dwordx4 v5, s[40:43], s54 offen nt lds
    s_add_u32 s54, s52, 0
    s_add_u32 s54, s54, s8
    s_add_u32 m0, s53, 0
    s_nop 0
    buffer_load_dwordx4 v4, s[40:43], s54 offen nt lds
    s_add_u32 s54, s52, 0
    s_add_u32 s54, s54, s9
    s_add_u32 m0, s53, 16384
    s_nop 0
    buffer_load_dwordx4 v4, s[40:43], s54 offen nt lds
    s_add_u32 s54, s52, 0
    s_add_u32 s54, s54, s10
    s_add_u32 m0, s53, 32768
    s_nop 0
    buffer_load_dwordx4 v4, s[40:43], s54 offen nt lds
    s_add_u32 s54, s52, 0
    s_add_u32 s54, s54, s11
    s_add_u32 m0, s53, 49152
    s_nop 0
    buffer_load_dwordx4 v4, s[40:43], s54 offen nt lds
    s_add_u32 s54, s52, 0
    s_add_u32 s54, s54, s12
    s_add_u32 m0, s53, 65536
    s_nop 0
    buffer_load_dwordx4 v4, s[40:43], s54 offen nt lds
    s_waitcnt vmcnt(8)
    s_add_u32 s54, s52, 1048576
    s_add_u32 s54, s54, s8
    s_add_u32 m0, s53, 1024
    s_nop 0
    buffer_load_dwordx4 v5, s[40:43], s54 offen nt lds
    s_waitcnt vmcnt(8)
    s_add_u32 s54, s52, 1048576
    s_add_u32 s54, s54, s9
    s_add_u32 m0, s53, 17408
    s_nop 0
    buffer_load_dwordx4 v5, s[40:43], s54 offen nt lds
    s_waitcnt vmcnt(8)
    s_add_u32 s54, s52, 1048576
    s_add_u32 s54, s54, s10
    s_add_u32 m0, s53, 33792
    s_nop 0
    buffer_load_dwordx4 v5, s[40:43], s54 offen nt lds
    s_waitcnt vmcnt(8)
    s_add_u32 s54, s52, 1048576
    s_add_u32 s54, s54, s11
    s_add_u32 m0, s53, 50176
    s_nop 0
    buffer_load_dwordx4 v5, s[40:43], s54 offen nt lds
    s_waitcnt vmcnt(8)
    ds_read_b128 v[176:179], v20 offset:49152
    ds_read_b128 v[180:183], v21 offset:49152
    ds_read_b128 v[184:187], v22 offset:49152
    ds_read_b128 v[188:191], v23 offset:49152
    ds_read_b128 v[224:227], v63 offset:0
    ds_read_b128 v[228:231], v63 offset:1024
    ds_read_b128 v[232:235], v63 offset:2048
    ds_read_b128 v[236:239], v63 offset:3072
    s_waitcnt lgkmcnt(0)
    ds_write_b32 v6, v7 offset:192
    s_add_u32 s54, s52, 1048576
    s_add_u32 s54, s54, s12
    s_add_u32 m0, s53, 66560
    s_nop 0
    buffer_load_dwordx4 v5, s[40:43], s54 offen nt lds
    s_waitcnt vmcnt(8)
    s_add_u32 s54, s52, 2097152
    s_add_u32 s54, s54, s8
    s_add_u32 m0, s53, 2048
    s_nop 0
    buffer_load_dwordx4 v4, s[40:43], s54 offen nt lds
    s_waitcnt vmcnt(8)
    s_add_u32 s54, s52, 2097152
    s_add_u32 s54, s54, s9
    s_add_u32 m0, s53, 18432
    s_nop 0
    buffer_load_dwordx4 v4, s[40:43], s54 offen nt lds
    s_waitcnt vmcnt(8)
    s_add_u32 s54, s52, 2097152
    s_add_u32 s54, s54, s10
    s_add_u32 m0, s53, 34816
    s_nop 0
    buffer_load_dwordx4 v4, s[40:43], s54 offen nt lds
    s_waitcnt vmcnt(8)
    s_add_u32 s54, s52, 2097152
    s_add_u32 s54, s54, s11
    s_add_u32 m0, s53, 51200
    s_nop 0
    buffer_load_dwordx4 v4, s[40:43], s54 offen nt lds
    s_waitcnt vmcnt(8)
    s_add_u32 s54, s52, 2097152
    s_add_u32 s54, s54, s12
    s_add_u32 m0, s53, 67584
    s_nop 0
    buffer_load_dwordx4 v4, s[40:43], s54 offen nt lds
    s_waitcnt vmcnt(8)
    s_add_u32 s54, s52, 3145728
    s_add_u32 s54, s54, s8
    s_add_u32 m0, s53, 3072
    s_nop 0
    buffer_load_dwordx4 v5, s[40:43], s54 offen nt lds
    s_waitcnt vmcnt(8)
    s_add_u32 s54, s52, 3145728
    s_add_u32 s54, s54, s9
    s_add_u32 m0, s53, 19456
    s_nop 0
    buffer_load_dwordx4 v5, s[40:43], s54 offen nt lds
    s_waitcnt vmcnt(8)
    s_add_u32 s54, s52, 3145728
    s_add_u32 s54, s54, s10
    s_add_u32 m0, s53, 35840
    s_nop 0
    buffer_load_dwordx4 v5, s[40:43], s54 offen nt lds
    s_waitcnt vmcnt(8)
    s_add_u32 s54, s52, 3145728
    s_add_u32 s54, s54, s11
    s_add_u32 m0, s53, 52224
    s_nop 0
    buffer_load_dwordx4 v5, s[40:43], s54 offen nt lds
    s_waitcnt vmcnt(8)
    s_add_u32 s54, s52, 3145728
    s_add_u32 s54, s54, s12
    s_add_u32 m0, s53, 68608
    s_nop 0
    buffer_load_dwordx4 v5, s[40:43], s54 offen nt lds
    s_waitcnt vmcnt(8)
    s_add_u32 s54, s52, 0
    s_add_u32 s54, s54, s13
    s_add_u32 m0, s53, 81920
    s_nop 0
    buffer_load_dwordx4 v4, s[40:43], s54 offen nt lds
    s_waitcnt vmcnt(8)
    s_add_u32 s54, s52, 0
    s_add_u32 s54, s54, s14
    s_add_u32 m0, s53, 98304
    s_nop 0
    buffer_load_dwordx4 v4, s[40:43], s54 offen nt lds
    s_waitcnt vmcnt(8)
    s_add_u32 s54, s52, 1048576
    s_add_u32 s54, s54, s13
    s_add_u32 m0, s53, 82944
    s_nop 0
    buffer_load_dwordx4 v5, s[40:43], s54 offen nt lds
    s_waitcnt vmcnt(8)
    s_add_u32 s54, s52, 1048576
    s_add_u32 s54, s54, s14
    s_add_u32 m0, s53, 99328
    s_nop 0
    buffer_load_dwordx4 v5, s[40:43], s54 offen nt lds
    s_waitcnt vmcnt(8)
    s_add_u32 s54, s52, 2097152
    s_add_u32 s54, s54, s13
    s_add_u32 m0, s53, 83968
    s_nop 0
    buffer_load_dwordx4 v4, s[40:43], s54 offen nt lds
    s_waitcnt vmcnt(8)
    s_add_u32 s54, s52, 2097152
    s_add_u32 s54, s54, s14
    s_add_u32 m0, s53, 100352
    s_nop 0
    buffer_load_dwordx4 v4, s[40:43], s54 offen nt lds
    s_waitcnt vmcnt(8)
    s_add_u32 s54, s52, 3145728
    s_add_u32 s54, s54, s13
    s_add_u32 m0, s53, 84992
    s_nop 0
    buffer_load_dwordx4 v5, s[40:43], s54 offen nt lds
    s_waitcnt vmcnt(8)
    s_add_u32 s54, s52, 3145728
    s_add_u32 s54, s54, s14
    s_add_u32 m0, s53, 101376
    s_nop 0
    buffer_load_dwordx4 v5, s[40:43], s54 offen nt lds
    s_mov_b32 s98, 3200000
wf_84:
    ds_read_b128 v[8:11], v2 offset:192
    s_waitcnt lgkmcnt(0)
    v_and_b32 v8, v8, v9
    v_and_b32 v10, v10, v11
    v_and_b32 v8, v8, v10
    s_nop 0
    v_readfirstlane_b32 s101, v8
    s_nop 0
    s_cmp_lg_u32 s101, 0
    s_cbranch_scc1 wfd_85
    s_sub_u32 s98, s98, 1
    s_cmp_lg_u32 s98, 0
    s_cbranch_scc1 wf_84
wfd_85:
    s_mov_b32 s0, s32
    s_mov_b32 s1, s32
    s_lshl_b32 s55, s34, 10
    s_add_u32 s56, s26, s55
    s_addc_u32 s57, s27, 0
    s_add_u32 s56, s56, 917504
    s_addc_u32 s57, s57, 0
    s_mov_b32 s55, 0
    s_load_dwordx16 s[80:95], s[56:57], s55
    s_add_u32 s55, s55, 64
    s_waitcnt lgkmcnt(0)
    s_xor_b64 s[80:81], s[80:81], s[0:1]
    s_xor_b64 s[82:83], s[82:83], s[0:1]
    s_xor_b64 s[84:85], s[84:85], s[0:1]
    s_xor_b64 s[86:87], s[86:87], s[0:1]
    s_xor_b64 s[88:89], s[88:89], s[0:1]
    s_xor_b64 s[90:91], s[90:91], s[0:1]
    s_xor_b64 s[92:93], s[92:93], s[0:1]
    s_xor_b64 s[94:95], s[94:95], s[0:1]
    s_or_b64 s[80:81], s[80:81], s[82:83]
    s_or_b64 s[80:81], s[80:81], s[84:85]
    s_or_b64 s[80:81], s[80:81], s[86:87]
    s_or_b64 s[80:81], s[80:81], s[88:89]
    s_or_b64 s[80:81], s[80:81], s[90:91]
    s_or_b64 s[80:81], s[80:81], s[92:93]
    s_or_b64 s[80:81], s[80:81], s[94:95]
    s_cmp_eq_u64 s[80:81], 0
    s_cbranch_scc1 gtd_87
    ds_write_b32 v6, v7 offset:64
gt_86:
    s_sleep 0
    s_load_dwordx16 s[80:95], s[56:57], s55
    s_add_u32 s55, s55, 64
    s_waitcnt lgkmcnt(0)
    s_xor_b64 s[80:81], s[80:81], s[0:1]
    s_xor_b64 s[82:83], s[82:83], s[0:1]
    s_xor_b64 s[84:85], s[84:85], s[0:1]
    s_xor_b64 s[86:87], s[86:87], s[0:1]
    s_xor_b64 s[88:89], s[88:89], s[0:1]
    s_xor_b64 s[90:91], s[90:91], s[0:1]
    s_xor_b64 s[92:93], s[92:93], s[0:1]
    s_xor_b64 s[94:95], s[94:95], s[0:1]
    s_or_b64 s[80:81], s[80:81], s[82:83]
    s_or_b64 s[80:81], s[80:81], s[84:85]
    s_or_b64 s[80:81], s[80:81], s[86:87]
    s_or_b64 s[80:81], s[80:81], s[88:89]
    s_or_b64 s[80:81], s[80:81], s[90:91]
    s_or_b64 s[80:81], s[80:81], s[92:93]
    s_or_b64 s[80:81], s[80:81], s[94:95]
    s_cmp_eq_u64 s[80:81], 0
    s_cbranch_scc1 gtd_87
    s_cmp_lt_u32 s55, 1024
    s_cbranch_scc1 gt_86
gtd_87:
    s_add_u32 m0, s58, 0
    s_add_u32 s54, s59, s8
    buffer_load_dwordx4 v61, s[36:39], s54 offen sc1 lds
    s_add_u32 m0, s58, 4096
    s_add_u32 s54, s59, s9
    buffer_load_dwordx4 v61, s[36:39], s54 offen sc1 lds
    s_add_u32 m0, s58, 8192
    s_add_u32 s54, s59, s10
    buffer_load_dwordx4 v61, s[36:39], s54 offen sc1 lds
    s_add_u32 m0, s58, 12288
    s_add_u32 s54, s59, s11
    buffer_load_dwordx4 v61, s[36:39], s54 offen sc1 lds
    s_add_u32 m0, s58, 16384
    s_add_u32 s54, s59, s12
    buffer_load_dwordx4 v61, s[36:39], s54 offen sc1 lds
    s_add_u32 m0, s58, 20480
    s_add_u32 s54, s59, s13
    buffer_load_dwordx4 v61, s[36:39], s54 offen sc1 lds
    s_add_u32 m0, s58, 24576
    s_add_u32 s54, s59, s14
    buffer_load_dwordx4 v61, s[36:39], s54 offen sc1 lds
    s_add_u32 m0, s58, 28672
    s_add_u32 s54, s59, s15
    buffer_load_dwordx4 v61, s[36:39], s54 offen sc1 lds
    ds_write_b32 v6, v7 offset:224
    ds_write_b32 v6, v7 offset:64
    v_lshlrev_b32 v8, 3, v60
    v_lshrrev_b64 v[8:9], v8, s[24:25]
    v_and_b32 v8, 0xff, v8
    v_lshl_or_b32 v8, v8, 15, v8
    v_lshrrev_b32 v48, 0, v8
    v_and_b32 v48, s62, v48
    v_lshrrev_b32 v49, 2, v8
    v_and_b32 v49, s62, v49
    v_lshrrev_b32 v50, 4, v8
    v_and_b32 v50, s62, v50
    v_lshrrev_b32 v51, 6, v8
    v_and_b32 v51, s62, v51
    s_waitcnt vmcnt(16)
    ds_read_b128 v[96:99], v16 offset:0
    ds_read_b128 v[100:103], v17 offset:0
    ds_read_b128 v[104:107], v18 offset:0
    ds_read_b128 v[108:111], v19 offset:0
    ds_read_b128 v[112:115], v16 offset:16384
    ds_read_b128 v[116:119], v17 offset:16384
    ds_read_b128 v[120:123], v18 offset:16384
    ds_read_b128 v[124:127], v19 offset:16384
    ds_read_b128 v[128:131], v16 offset:32768
    ds_read_b128 v[132:135], v17 offset:32768
    ds_read_b128 v[136:139], v18 offset:32768
    ds_read_b128 v[140:143], v19 offset:32768
    ds_read_b128 v[144:147], v16 offset:49152
    ds_read_b128 v[148:151], v17 offset:49152
    ds_read_b128 v[152:155], v18 offset:49152
    ds_read_b128 v[156:159], v19 offset:49152
    ds_read_b128 v[160:163], v20 offset:0
    ds_read_b128 v[164:167], v21 offset:0
    ds_read_b128 v[168:171], v22 offset:0
    ds_read_b128 v[172:175], v23 offset:0
    s_mov_b32 s98, 200000
    s_waitcnt vmcnt(0)
    s_branch qlc_90
ql_88:
    s_add_u32 m0, s58, 0
    s_add_u32 s54, s59, s8
    buffer_load_dwordx4 v61, s[36:39], s54 offen sc1 lds
    s_add_u32 m0, s58, 4096
    s_add_u32 s54, s59, s9
    buffer_load_dwordx4 v61, s[36:39], s54 offen sc1 lds
    s_add_u32 m0, s58, 8192
    s_add_u32 s54, s59, s10
    buffer_load_dwordx4 v61, s[36:39], s54 offen sc1 lds
    s_add_u32 m0, s58, 12288
    s_add_u32 s54, s59, s11
    buffer_load_dwordx4 v61, s[36:39], s54 offen sc1 lds
    s_add_u32 m0, s58, 16384
    s_add_u32 s54, s59, s12
    buffer_load_dwordx4 v61, s[36:39], s54 offen sc1 lds
    s_add_u32 m0, s58, 20480
    s_add_u32 s54, s59, s13
    buffer_load_dwordx4 v61, s[36:39], s54 offen sc1 lds
    s_add_u32 m0, s58, 24576
    s_add_u32 s54, s59, s14
    buffer_load_dwordx4 v61, s[36:39], s54 offen sc1 lds
    s_add_u32 m0, s58, 28672
    s_add_u32 s54, s59, s15
    buffer_load_dwordx4 v61, s[36:39], s54 offen sc1 lds
qlw_91:
    s_waitcnt vmcnt(0)
qlc_90:
    ds_read_b64 v[64:65], v62 offset:0
    ds_read_b64 v[66:67], v62 offset:4096
    ds_read_b64 v[68:69], v62 offset:8192
    ds_read_b64 v[70:71], v62 offset:12288
    ds_read_b64 v[72:73], v62 offset:16384
    ds_read_b64 v[74:75], v62 offset:20480
    ds_read_b64 v[76:77], v62 offset:24576
    ds_read_b64 v[78:79], v62 offset:28672
    s_waitcnt lgkmcnt(7)
    v_xor_b32 v52, v64, v48
    v_xor_b32 v53, v65, v49
    s_waitcnt lgkmcnt(6)
    v_bitop3_b32 v52, v66, v48, v52 bitop3:0xbe
    v_bitop3_b32 v53, v67, v49, v53 bitop3:0xbe
    s_waitcnt lgkmcnt(5)
    v_bitop3_b32 v52, v68, v48, v52 bitop3:0xbe
    v_bitop3_b32 v53, v69, v49, v53 bitop3:0xbe
    s_waitcnt lgkmcnt(4)
    v_bitop3_b32 v52, v70, v48, v52 bitop3:0xbe
    v_bitop3_b32 v53, v71, v49, v53 bitop3:0xbe
    s_waitcnt lgkmcnt(3)
    v_bitop3_b32 v52, v72, v48, v52 bitop3:0xbe
    v_bitop3_b32 v53, v73, v49, v53 bitop3:0xbe
    s_waitcnt lgkmcnt(2)
    v_bitop3_b32 v52, v74, v48, v52 bitop3:0xbe
    v_bitop3_b32 v53, v75, v49, v53 bitop3:0xbe
    s_waitcnt lgkmcnt(1)
    v_bitop3_b32 v52, v76, v48, v52 bitop3:0xbe
    v_bitop3_b32 v53, v77, v49, v53 bitop3:0xbe
    s_waitcnt lgkmcnt(0)
    v_bitop3_b32 v52, v78, v48, v52 bitop3:0xbe
    v_bitop3_b32 v53, v79, v49, v53 bitop3:0xbe
    v_or_b32 v52, v52, v53
    v_and_b32 v52, s62, v52
    v_cmp_ne_u32 vcc, 0, v52
    s_cbranch_vccz qld_89
    s_sub_u32 s98, s98, 1
    s_cmp_lg_u32 s98, 0
    s_cbranch_scc1 ql_88
qld_89:
    ds_write_b32 v6, v7 offset:32
    s_setprio 1
    s_mov_b32 s98, 3200000
wf_92:
    ds_read_b128 v[8:11], v2 offset:32
    s_waitcnt lgkmcnt(0)
    v_and_b32 v8, v8, v9
    v_and_b32 v10, v10, v11
    v_and_b32 v8, v8, v10
    s_nop 0
    v_readfirstlane_b32 s101, v8
    s_nop 0
    s_cmp_lg_u32 s101, 0
    s_cbranch_scc1 wfd_93
    s_sub_u32 s98, s98, 1
    s_cmp_lg_u32 s98, 0
    s_cbranch_scc1 wf_92
wfd_93:
    s_mov_b32 s55, 0xfffefffe
    ds_read_b128 v[64:67], v12 offset:0
    ds_read_b128 v[68:71], v13 offset:0
    ds_read_b128 v[72:75], v14 offset:0
    ds_read_b128 v[76:79], v15 offset:0
    ds_read_b128 v[80:83], v12 offset:4096
    ds_read_b128 v[84:87], v13 offset:4096
    ds_read_b128 v[88:91], v14 offset:4096
    ds_read_b128 v[92:95], v15 offset:4096
    s_waitcnt lgkmcnt(7)
    v_and_b32 v64, s55, v64
    v_and_b32 v65, s55, v65
    s_waitcnt lgkmcnt(6)
    s_nop 0
    v_mfma_f32_32x32x16_bf16 v[32:47], v[96:99], v[64:67], 0
    v_and_b32 v68, s55, v68
    v_and_b32 v69, s55, v69
    ds_read_b128 v[96:99], v12 offset:8192
    s_waitcnt lgkmcnt(6)
    v_mfma_f32_32x32x16_bf16 v[32:47], v[100:103], v[68:71], v[32:47]
    v_and_b32 v72, s55, v72
    v_and_b32 v73, s55, v73
    ds_read_b128 v[100:103], v13 offset:8192
    s_waitcnt lgkmcnt(6)
    v_mfma_f32_32x32x16_bf16 v[32:47], v[104:107], v[72:75], v[32:47]
    v_and_b32 v76, s55, v76
    v_and_b32 v77, s55, v77
    ds_read_b128 v[104:107], v14 offset:8192
    s_waitcnt lgkmcnt(6)
    v_mfma_f32_32x32x16_bf16 v[32:47], v[108:111], v[76:79], v[32:47]
    v_and_b32 v80, s55, v80
    v_and_b32 v81, s55, v81
    ds_read_b128 v[108:111], v15 offset:8192
    s_waitcnt lgkmcnt(6)
    v_mfma_f32_32x32x16_bf16 v[32:47], v[112:115], v[80:83], v[32:47]
    v_and_b32 v84, s55, v84
    v_and_b32 v85, s55, v85
    ds_read_b128 v[112:115], v12 offset:12288
    s_waitcnt lgkmcnt(6)
    v_mfma_f32_32x32x16_bf16 v[32:47], v[116:119], v[84:87], v[32:47]
    v_and_b32 v88, s55, v88
    v_and_b32 v89, s55, v89
    ds_read_b128 v[116:119], v13 offset:12288
    s_waitcnt lgkmcnt(6)
    v_mfma_f32_32x32x16_bf16 v[32:47], v[120:123], v[88:91], v[32:47]
    v_and_b32 v92, s55, v92
    v_and_b32 v93, s55, v93
    ds_read_b128 v[120:123], v14 offset:12288
    s_waitcnt lgkmcnt(6)
    v_mfma_f32_32x32x16_bf16 v[32:47], v[124:127], v[92:95], v[32:47]
    v_and_b32 v96, s55, v96
    v_and_b32 v97, s55, v97
    ds_read_b128 v[124:127], v15 offset:12288
    s_waitcnt lgkmcnt(6)
    v_mfma_f32_32x32x16_bf16 v[32:47], v[128:131], v[96:99], v[32:47]
    v_and_b32 v100, s55, v100
    v_and_b32 v101, s55, v101
    ds_read_b128 v[128:131], v12 offset:16384
    s_waitcnt lgkmcnt(6)
    v_mfma_f32_32x32x16_bf16 v[32:47], v[132:135], v[100:103], v[32:47]
    v_and_b32 v104, s55, v104
    v_and_b32 v105, s55, v105
    ds_read_b128 v[132:135], v13 offset:16384
    s_waitcnt lgkmcnt(6)
    v_mfma_f32_32x32x16_bf16 v[32:47], v[136:139], v[104:107], v[32:47]
    v_and_b32 v108, s55, v108
    v_and_b32 v109, s55, v109
    ds_read_b128 v[136:139], v14 offset:16384
    s_waitcnt lgkmcnt(6)
    v_mfma_f32_32x32x16_bf16 v[32:47], v[140:143], v[108:111], v[32:47]
    v_and_b32 v112, s55, v112
    v_and_b32 v113, s55, v113
    ds_read_b128 v[140:143], v15 offset:16384
    s_waitcnt lgkmcnt(6)
    v_mfma_f32_32x32x16_bf16 v[32:47], v[144:147], v[112:115], v[32:47]
    v_and_b32 v116, s55, v116
    v_and_b32 v117, s55, v117
    ds_read_b128 v[144:147], v12 offset:28672
    s_waitcnt lgkmcnt(6)
    v_mfma_f32_32x32x16_bf16 v[32:47], v[148:151], v[116:119], v[32:47]
    v_and_b32 v120, s55, v120
    v_and_b32 v121, s55, v121
    ds_read_b128 v[148:151], v13 offset:28672
    s_waitcnt lgkmcnt(6)
    v_mfma_f32_32x32x16_bf16 v[32:47], v[152:155], v[120:123], v[32:47]
    v_and_b32 v124, s55, v124
    v_and_b32 v125, s55, v125
    ds_read_b128 v[152:155], v14 offset:28672
    s_waitcnt lgkmcnt(6)
    v_mfma_f32_32x32x16_bf16 v[32:47], v[156:159], v[124:127], v[32:47]
    v_and_b32 v128, s55, v128
    v_and_b32 v129, s55, v129
    ds_read_b128 v[156:159], v15 offset:28672
    ds_write_b32 v6, v7 offset:48
    s_waitcnt lgkmcnt(7)
    v_mfma_f32_32x32x16_bf16 v[32:47], v[160:163], v[128:131], v[32:47]
    v_and_b32 v132, s55, v132
    v_and_b32 v133, s55, v133
    ds_read_b128 v[160:163], v12 offset:20480
    s_waitcnt lgkmcnt(7)
    v_mfma_f32_32x32x16_bf16 v[32:47], v[164:167], v[132:135], v[32:47]
    v_and_b32 v136, s55, v136
    v_and_b32 v137, s55, v137
    ds_read_b128 v[164:167], v13 offset:20480
    s_waitcnt lgkmcnt(7)
    v_mfma_f32_32x32x16_bf16 v[32:47], v[168:171], v[136:139], v[32:47]
    v_and_b32 v140, s55, v140
    v_and_b32 v141, s55, v141
    ds_read_b128 v[168:171], v14 offset:20480
    s_waitcnt lgkmcnt(7)
    v_mfma_f32_32x32x16_bf16 v[32:47], v[172:175], v[140:143], v[32:47]
    v_and_b32 v144, s55, v144
    v_and_b32 v145, s55, v145
    ds_read_b128 v[172:175], v15 offset:20480
    s_waitcnt vmcnt(0)
    ds_read_b128 v[192:195], v20 offset:16384
    ds_read_b128 v[196:199], v21 offset:16384
    ds_read_b128 v[200:203], v22 offset:16384
    ds_read_b128 v[204:207], v23 offset:16384
    ds_read_b128 v[208:211], v20 offset:32768
    ds_read_b128 v[212:215], v21 offset:32768
    ds_read_b128 v[216:219], v22 offset:32768
    ds_read_b128 v[220:223], v23 offset:32768
    s_waitcnt lgkmcnt(15)
    v_mfma_f32_32x32x16_bf16 v[32:47], v[176:179], v[144:147], v[32:47]
    v_and_b32 v148, s55, v148
    v_and_b32 v149, s55, v149
    ds_read_b128 v[176:179], v12 offset:24576
    s_waitcnt lgkmcnt(15)
    v_mfma_f32_32x32x16_bf16 v[32:47], v[180:183], v[148:151], v[32:47]
    v_and_b32 v152, s55, v152
    v_and_b32 v153, s55, v153
    ds_read_b128 v[180:183], v13 offset:24576
    s_waitcnt lgkmcnt(15)
    v_mfma_f32_32x32x16_bf16 v[32:47], v[184:187], v[152:155], v[32:47]
    v_and_b32 v156, s55, v156
    v_and_b32 v157, s55, v157
    ds_read_b128 v[184:187], v14 offset:24576
    s_waitcnt lgkmcnt(14)
    v_mfma_f32_32x32x16_bf16 v[32:47], v[188:191], v[156:159], v[32:47]
    v_and_b32 v160, s55, v160
    v_and_b32 v161, s55, v161
    ds_read_b128 v[188:191], v15 offset:24576
    s_waitcnt lgkmcnt(11)
    v_mfma_f32_32x32x16_bf16 v[32:47], v[192:195], v[160:163], v[32:47]
    v_and_b32 v164, s55, v164
    v_and_b32 v165, s55, v165
    s_waitcnt lgkmcnt(10)
    s_nop 0
    v_mfma_f32_32x32x16_bf16 v[32:47], v[196:199], v[164:167], v[32:47]
    v_and_b32 v168, s55, v168
    v_and_b32 v169, s55, v169
    s_waitcnt lgkmcnt(9)
    s_nop 0
    v_mfma_f32_32x32x16_bf16 v[32:47], v[200:203], v[168:171], v[32:47]
    v_and_b32 v172, s55, v172
    v_and_b32 v173, s55, v173
    s_waitcnt lgkmcnt(3)
    s_nop 0
    v_mfma_f32_32x32x16_bf16 v[32:47], v[204:207], v[172:175], v[32:47]
    v_and_b32 v176, s55, v176
    v_and_b32 v177, s55, v177
    s_waitcnt lgkmcnt(2)
    s_nop 0
    v_mfma_f32_32x32x16_bf16 v[32:47], v[208:211], v[176:179], v[32:47]
    v_and_b32 v180, s55, v180
    v_and_b32 v181, s55, v181
    s_waitcnt lgkmcnt(1)
    s_nop 0
    v_mfma_f32_32x32x16_bf16 v[32:47], v[212:215], v[180:183], v[32:47]
    v_and_b32 v184, s55, v184
    v_and_b32 v185, s55, v185
    s_waitcnt lgkmcnt(0)
    s_nop 0
    v_mfma_f32_32x32x16_bf16 v[32:47], v[216:219], v[184:187], v[32:47]
    v_and_b32 v188, s55, v188
    v_and_b32 v189, s55, v189
    s_waitcnt lgkmcnt(0)
    s_nop 0
    v_mfma_f32_32x32x16_bf16 v[32:47], v[220:223], v[188:191], v[32:47]
    s_mov_b32 s98, 3200000
wf_94:
    ds_read_b128 v[8:11], v2 offset:48
    s_waitcnt lgkmcnt(0)
    v_and_b32 v8, v8, v9
    v_and_b32 v10, v10, v11
    v_and_b32 v8, v8, v10
    s_nop 0
    v_readfirstlane_b32 s101, v8
    s_nop 0
    s_cmp_lg_u32 s101, 0
    s_cbranch_scc1 wfd_95
    s_sub_u32 s98, s98, 1
    s_cmp_lg_u32 s98, 0
    s_cbranch_scc1 wf_94
wfd_95:
    ds_write_b128 v63, v[224:227] offset:0
    ds_write_b128 v63, v[228:231] offset:1024
    ds_write_b128 v63, v[232:235] offset:2048
    ds_write_b128 v63, v[236:239] offset:3072
    v_max3_f32 v8, v32, v33, v34
    v_max3_f32 v9, v35, v36, v37
    v_max3_f32 v10, v38, v39, v40
    v_max3_f32 v11, v41, v42, v43
    v_max3_f32 v8, v8, v44, v45
    v_max3_f32 v9, v9, v46, v47
    v_max3_f32 v8, v8, v9, v10
    v_max_f32 v8, v8, v11
    v_max_f32 v9, v8, v11
    s_nop 1
    v_permlane32_swap_b32 v8, v9
    v_max_f32 v8, v8, v9
    ds_write_b32 v25, v8 offset:256
    ds_write_b32 v6, v7 offset:80
    s_mov_b32 s98, 3200000
mx_96:
    ds_read_b128 v[12:15], v2 offset:80
    ds_read_b128 v[8:11], v24 offset:256
    s_waitcnt lgkmcnt(0)
    v_and_b32 v12, v12, v13
    v_and_b32 v14, v14, v15
    v_and_b32 v12, v12, v14
    v_max3_f32 v8, v8, v9, v10
    v_readfirstlane_b32 s101, v12
    v_max_f32 v8, v8, v11
    s_cmp_lg_u32 s101, 0
    s_cbranch_scc1 mxd_97
    s_sub_u32 s98, s98, 1
    s_cmp_lg_u32 s98, 0
    s_cbranch_scc1 mx_96
mxd_97:
    v_sub_f32 v32, v32, v8
    v_sub_f32 v33, v33, v8
    v_sub_f32 v34, v34, v8
    v_sub_f32 v35, v35, v8
    v_sub_f32 v36, v36, v8
    v_sub_f32 v37, v37, v8
    v_sub_f32 v38, v38, v8
    v_sub_f32 v39, v39, v8
    v_sub_f32 v40, v40, v8
    v_sub_f32 v41, v41, v8
    v_sub_f32 v42, v42, v8
    v_sub_f32 v43, v43, v8
    v_sub_f32 v44, v44, v8
    v_sub_f32 v45, v45, v8
    v_sub_f32 v46, v46, v8
    v_sub_f32 v47, v47, v8
    v_exp_f32 v32, v32
    ds_read_b64_tr_b16 v[192:193], v28 offset:0
    v_exp_f32 v33, v33
    ds_read_b64_tr_b16 v[194:195], v30 offset:1024
    v_exp_f32 v34, v34
    ds_read_b64_tr_b16 v[196:197], v29 offset:0
    v_exp_f32 v35, v35
    ds_read_b64_tr_b16 v[198:199], v31 offset:1024
    v_exp_f32 v36, v36
    ds_read_b64_tr_b16 v[200:201], v28 offset:2048
    v_exp_f32 v37, v37
    ds_read_b64_tr_b16 v[202:203], v30 offset:3072
    v_exp_f32 v38, v38
    ds_read_b64_tr_b16 v[204:205], v29 offset:2048
    v_exp_f32 v39, v39
    ds_read_b64_tr_b16 v[206:207], v31 offset:3072
    v_exp_f32 v40, v40
    ds_read_b64_tr_b16 v[208:209], v28 offset:4096
    v_exp_f32 v41, v41
    ds_read_b64_tr_b16 v[210:211], v30 offset:5120
    v_exp_f32 v42, v42
    ds_read_b64_tr_b16 v[212:213], v29 offset:4096
    v_exp_f32 v43, v43
    ds_read_b64_tr_b16 v[214:215], v31 offset:5120
    v_exp_f32 v44, v44
    ds_read_b64_tr_b16 v[216:217], v28 offset:6144
    v_exp_f32 v45, v45
    ds_read_b64_tr_b16 v[218:219], v30 offset:7168
    v_exp_f32 v46, v46
    ds_read_b64_tr_b16 v[220:221], v29 offset:6144
    v_exp_f32 v47, v47
    ds_read_b64_tr_b16 v[222:223], v31 offset:7168
    v_cvt_pk_bf16_f32 v48, v32, v33
    v_cvt_pk_bf16_f32 v49, v34, v35
    v_cvt_pk_bf16_f32 v50, v36, v37
    v_cvt_pk_bf16_f32 v51, v38, v39
    ds_write_b128 v26, v[48:51]
    v_cvt_pk_bf16_f32 v52, v40, v41
    v_cvt_pk_bf16_f32 v53, v42, v43
    v_cvt_pk_bf16_f32 v54, v44, v45
    v_cvt_pk_bf16_f32 v55, v46, v47
    ds_write_b128 v26, v[52:55] offset:1024
    s_waitcnt lgkmcnt(0)
    s_barrier
    s_setprio 0
    v_add_f32 v32, v32, v40
    v_add_f32 v33, v33, v41
    v_add_f32 v34, v34, v42
    v_add_f32 v35, v35, v43
    v_add_f32 v36, v36, v44
    v_add_f32 v37, v37, v45
    v_add_f32 v38, v38, v46
    v_add_f32 v39, v39, v47
    v_add_f32 v32, v32, v36
    v_add_f32 v33, v33, v37
    v_add_f32 v34, v34, v38
    v_add_f32 v35, v35, v39
    v_add_f32 v32, v32, v34
    v_add_f32 v33, v33, v35
    v_add_f32 v15, v32, v33
    v_sub_f32 v32, 0, v8
    v_sub_f32 v33, 0, v8
    v_sub_f32 v34, 0, v8
    v_sub_f32 v35, 0, v8
    v_sub_f32 v36, 0, v8
    v_sub_f32 v37, 0, v8
    v_sub_f32 v38, 0, v8
    v_sub_f32 v39, 0, v8
    v_sub_f32 v40, 0, v8
    v_sub_f32 v41, 0, v8
    v_sub_f32 v42, 0, v8
    v_sub_f32 v43, 0, v8
    v_sub_f32 v44, 0, v8
    v_sub_f32 v45, 0, v8
    v_sub_f32 v46, 0, v8
    v_sub_f32 v47, 0, v8
    s_lshl_b32 s58, s31, 2
    s_add_u32 s57, s31, 5
    s_cmp_ge_u32 s31, 2
    s_cselect_b32 s58, s57, s58
    s_cselect_b32 s59, 2, 1
    ds_read_b128 v[48:51], v27 offset:0
    ds_read_b128 v[52:55], v27 offset:1024
    ds_read_b128 v[56:59], v27 offset:2048
    ds_read_b128 v[60:63], v27 offset:3072
    s_waitcnt lgkmcnt(3)
    v_mfma_f32_32x32x16_bf16 v[224:239], v[192:195], v[48:51], 0
    ds_read_b64_tr_b16 v[192:193], v28 offset:8192
    ds_read_b64_tr_b16 v[194:195], v30 offset:9216
    v_mfma_f32_32x32x16_bf16 v[240:255], v[196:199], v[48:51], 0
    ds_read_b64_tr_b16 v[196:197], v29 offset:8192
    ds_read_b64_tr_b16 v[198:199], v31 offset:9216
    ds_read_b128 v[48:51], v27 offset:4096
    s_waitcnt lgkmcnt(7)
    v_mfma_f32_32x32x16_bf16 v[224:239], v[200:203], v[52:55], v[224:239]
    ds_read_b64_tr_b16 v[200:201], v28 offset:10240
    ds_read_b64_tr_b16 v[202:203], v30 offset:11264
    v_mfma_f32_32x32x16_bf16 v[240:255], v[204:207], v[52:55], v[240:255]
    ds_read_b64_tr_b16 v[204:205], v29 offset:10240
    ds_read_b64_tr_b16 v[206:207], v31 offset:11264
    ds_read_b128 v[52:55], v27 offset:5120
    s_waitcnt lgkmcnt(11)
    v_mfma_f32_32x32x16_bf16 v[224:239], v[208:211], v[56:59], v[224:239]
    ds_read_b64_tr_b16 v[208:209], v28 offset:12288
    ds_read_b64_tr_b16 v[210:211], v30 offset:13312
    v_mfma_f32_32x32x16_bf16 v[240:255], v[212:215], v[56:59], v[240:255]
    ds_read_b64_tr_b16 v[212:213], v29 offset:12288
    ds_read_b64_tr_b16 v[214:215], v31 offset:13312
    ds_read_b128 v[56:59], v27 offset:6144
    s_waitcnt lgkmcnt(15)
    v_mfma_f32_32x32x16_bf16 v[224:239], v[216:219], v[60:63], v[224:239]
    ds_read_b64_tr_b16 v[216:217], v28 offset:14336
    ds_read_b64_tr_b16 v[218:219], v30 offset:15360
    v_mfma_f32_32x32x16_bf16 v[240:255], v[220:223], v[60:63], v[240:255]
    ds_read_b64_tr_b16 v[220:221], v29 offset:14336
    ds_read_b64_tr_b16 v[222:223], v31 offset:15360
    ds_read_b128 v[60:63], v27 offset:7168
    s_waitcnt lgkmcnt(15)
    v_mfma_f32_32x32x16_bf16 v[224:239], v[192:195], v[48:51], v[224:239]
    v_mfma_f32_32x32x16_bf16 v[240:255], v[196:199], v[48:51], v[240:255]
    s_waitcnt lgkmcnt(10)
    v_mfma_f32_32x32x16_bf16 v[224:239], v[200:203], v[52:55], v[224:239]
    v_mfma_f32_32x32x16_bf16 v[240:255], v[204:207], v[52:55], v[240:255]
    s_waitcnt lgkmcnt(5)
    v_mfma_f32_32x32x16_bf16 v[224:239], v[208:211], v[56:59], v[224:239]
    v_mfma_f32_32x32x16_bf16 v[240:255], v[212:215], v[56:59], v[240:255]
    s_waitcnt lgkmcnt(0)
    s_barrier
    v_mfma_f32_32x32x16_bf16 v[224:239], v[216:219], v[60:63], v[224:239]
    v_mfma_f32_32x32x16_bf16 v[240:255], v[220:223], v[60:63], v[240:255]
    s_setprio 1
    s_mov_b32 s57, 0
    s_add_u32 s58, s58, s59
    s_cmp_ge_u32 s57, s58
    s_cbranch_scc1 wbd_99
    s_mov_b32 s98, 3200000
wb_98:
    ds_read_b128 v[8:11], v2 offset:160
    s_waitcnt lgkmcnt(0)
wbc_100:
    v_min3_u32 v8, v8, v9, v10
    v_min_u32 v8, v8, v11
    s_nop 0
    v_readfirstlane_b32 s57, v8
    s_nop 0
    s_cmp_ge_u32 s57, s58
    s_cbranch_scc1 wbd_99
    s_sub_u32 s98, s98, 1
    s_cmp_lg_u32 s98, 0
    s_cbranch_scc1 wb_98
wbd_99:
    ds_read_b128 v[192:195], v16 offset:0
    ds_read_b128 v[196:199], v17 offset:0
    ds_read_b128 v[200:203], v18 offset:0
    ds_read_b128 v[204:207], v19 offset:0
    ds_read_b128 v[208:211], v16 offset:16384
    ds_read_b128 v[212:215], v17 offset:16384
    ds_read_b128 v[216:219], v18 offset:16384
    ds_read_b128 v[220:223], v19 offset:16384
    ds_read_b128 v[8:11], v2 offset:160
    s_waitcnt lgkmcnt(8)
    v_mfma_f32_32x32x16_bf16 v[32:47], v[192:195], v[64:67], v[32:47]
    s_waitcnt lgkmcnt(7)
    v_mfma_f32_32x32x16_bf16 v[32:47], v[196:199], v[68:71], v[32:47]
    s_waitcnt lgkmcnt(6)
    v_mfma_f32_32x32x16_bf16 v[32:47], v[200:203], v[72:75], v[32:47]
    s_waitcnt lgkmcnt(5)
    v_mfma_f32_32x32x16_bf16 v[32:47], v[204:207], v[76:79], v[32:47]
    s_add_u32 s58, s58, s59
    s_cmp_ge_u32 s57, s58
    s_cbranch_scc1 wbd_102
    s_mov_b32 s98, 3200000
    s_waitcnt lgkmcnt(0)
    s_branch wbc_103
wb_101:
    ds_read_b128 v[8:11], v2 offset:160
    s_waitcnt lgkmcnt(0)
wbc_103:
    v_min3_u32 v8, v8, v9, v10
    v_min_u32 v8, v8, v11
    s_nop 0
    v_readfirstlane_b32 s57, v8
    s_nop 0
    s_cmp_ge_u32 s57, s58
    s_cbranch_scc1 wbd_102
    s_sub_u32 s98, s98, 1
    s_cmp_lg_u32 s98, 0
    s_cbranch_scc1 wb_101
wbd_102:
    s_waitcnt lgkmcnt(0)
    ds_read_b128 v[192:195], v16 offset:32768
    v_mfma_f32_32x32x16_bf16 v[32:47], v[208:211], v[80:83], v[32:47]
    ds_read_b128 v[196:199], v17 offset:32768
    v_mfma_f32_32x32x16_bf16 v[32:47], v[212:215], v[84:87], v[32:47]
    ds_read_b128 v[200:203], v18 offset:32768
    v_mfma_f32_32x32x16_bf16 v[32:47], v[216:219], v[88:91], v[32:47]
    ds_read_b128 v[204:207], v19 offset:32768
    v_mfma_f32_32x32x16_bf16 v[32:47], v[220:223], v[92:95], v[32:47]
    ds_read_b128 v[208:211], v16 offset:49152
    ds_read_b128 v[212:215], v17 offset:49152
    ds_read_b128 v[216:219], v18 offset:49152
    ds_read_b128 v[220:223], v19 offset:49152
    ds_read_b128 v[8:11], v2 offset:160
    s_waitcnt lgkmcnt(8)
    v_mfma_f32_32x32x16_bf16 v[32:47], v[192:195], v[96:99], v[32:47]
    s_waitcnt lgkmcnt(7)
    v_mfma_f32_32x32x16_bf16 v[32:47], v[196:199], v[100:103], v[32:47]
    s_waitcnt lgkmcnt(6)
    v_mfma_f32_32x32x16_bf16 v[32:47], v[200:203], v[104:107], v[32:47]
    s_waitcnt lgkmcnt(5)
    v_mfma_f32_32x32x16_bf16 v[32:47], v[204:207], v[108:111], v[32:47]
    s_add_u32 s58, s58, s59
    s_cmp_ge_u32 s57, s58
    s_cbranch_scc1 wbd_105
    s_mov_b32 s98, 3200000
    s_waitcnt lgkmcnt(0)
    s_branch wbc_106
wb_104:
    ds_read_b128 v[8:11], v2 offset:160
    s_waitcnt lgkmcnt(0)
wbc_106:
    v_min3_u32 v8, v8, v9, v10
    v_min_u32 v8, v8, v11
    s_nop 0
    v_readfirstlane_b32 s57, v8
    s_nop 0
    s_cmp_ge_u32 s57, s58
    s_cbranch_scc1 wbd_105
    s_sub_u32 s98, s98, 1
    s_cmp_lg_u32 s98, 0
    s_cbranch_scc1 wb_104
wbd_105:
    s_waitcnt lgkmcnt(0)
    ds_read_b128 v[192:195], v20 offset:0
    v_mfma_f32_32x32x16_bf16 v[32:47], v[208:211], v[112:115], v[32:47]
    ds_read_b128 v[196:199], v21 offset:0
    v_mfma_f32_32x32x16_bf16 v[32:47], v[212:215], v[116:119], v[32:47]
    ds_read_b128 v[200:203], v22 offset:0
    v_mfma_f32_32x32x16_bf16 v[32:47], v[216:219], v[120:123], v[32:47]
    ds_read_b128 v[204:207], v23 offset:0
    v_mfma_f32_32x32x16_bf16 v[32:47], v[220:223], v[124:127], v[32:47]
    ds_read_b128 v[208:211], v20 offset:16384
    ds_read_b128 v[212:215], v21 offset:16384
    ds_read_b128 v[216:219], v22 offset:16384
    ds_read_b128 v[220:223], v23 offset:16384
    s_waitcnt lgkmcnt(7)
    v_mfma_f32_32x32x16_bf16 v[32:47], v[192:195], v[128:131], v[32:47]
    s_waitcnt lgkmcnt(6)
    v_mfma_f32_32x32x16_bf16 v[32:47], v[196:199], v[132:135], v[32:47]
    s_waitcnt lgkmcnt(5)
    v_mfma_f32_32x32x16_bf16 v[32:47], v[200:203], v[136:139], v[32:47]
    s_waitcnt lgkmcnt(4)
    v_mfma_f32_32x32x16_bf16 v[32:47], v[204:207], v[140:143], v[32:47]
    ds_read_b128 v[8:11], v2 offset:160
    s_waitcnt lgkmcnt(4)
    v_mfma_f32_32x32x16_bf16 v[32:47], v[208:211], v[160:163], v[32:47]
    s_waitcnt lgkmcnt(3)
    v_mfma_f32_32x32x16_bf16 v[32:47], v[212:215], v[164:167], v[32:47]
    s_waitcnt lgkmcnt(2)
    v_mfma_f32_32x32x16_bf16 v[32:47], v[216:219], v[168:171], v[32:47]
    s_waitcnt lgkmcnt(1)
    v_mfma_f32_32x32x16_bf16 v[32:47], v[220:223], v[172:175], v[32:47]
    s_add_u32 s58, s58, s59
    s_cmp_ge_u32 s57, s58
    s_cbranch_scc1 wbd_108
    s_mov_b32 s98, 3200000
    s_waitcnt lgkmcnt(0)
    s_branch wbc_109
wb_107:
    ds_read_b128 v[8:11], v2 offset:160
    s_waitcnt lgkmcnt(0)
wbc_109:
    v_min3_u32 v8, v8, v9, v10
    v_min_u32 v8, v8, v11
    s_nop 0
    v_readfirstlane_b32 s57, v8
    s_nop 0
    s_cmp_ge_u32 s57, s58
    s_cbranch_scc1 wbd_108
    s_sub_u32 s98, s98, 1
    s_cmp_lg_u32 s98, 0
    s_cbranch_scc1 wb_107
wbd_108:
    ds_read_b128 v[192:195], v20 offset:32768
    ds_read_b128 v[196:199], v21 offset:32768
    ds_read_b128 v[200:203], v22 offset:32768
    ds_read_b128 v[204:207], v23 offset:32768
    ds_read_b128 v[208:211], v20 offset:49152
    ds_read_b128 v[212:215], v21 offset:49152
    ds_read_b128 v[216:219], v22 offset:49152
    ds_read_b128 v[220:223], v23 offset:49152
    s_waitcnt lgkmcnt(7)
    v_mfma_f32_32x32x16_bf16 v[32:47], v[192:195], v[176:179], v[32:47]
    s_waitcnt lgkmcnt(6)
    v_mfma_f32_32x32x16_bf16 v[32:47], v[196:199], v[180:183], v[32:47]
    s_waitcnt lgkmcnt(5)
    v_mfma_f32_32x32x16_bf16 v[32:47], v[200:203], v[184:187], v[32:47]
    s_waitcnt lgkmcnt(4)
    v_mfma_f32_32x32x16_bf16 v[32:47], v[204:207], v[188:191], v[32:47]
    s_waitcnt lgkmcnt(3)
    v_mfma_f32_32x32x16_bf16 v[32:47], v[208:211], v[144:147], v[32:47]
    s_waitcnt lgkmcnt(2)
    v_mfma_f32_32x32x16_bf16 v[32:47], v[212:215], v[148:151], v[32:47]
    s_waitcnt lgkmcnt(1)
    v_mfma_f32_32x32x16_bf16 v[32:47], v[216:219], v[152:155], v[32:47]
    s_waitcnt lgkmcnt(0)
    v_mfma_f32_32x32x16_bf16 v[32:47], v[220:223], v[156:159], v[32:47]
    s_cmp_lg_u32 s31, 0
    s_cbranch_scc1 a0_110
    s_mov_b32 s58, 7
    s_add_u32 s58, s58, s59
    s_cmp_ge_u32 s57, s58
    s_cbranch_scc1 wbd_114
    s_mov_b32 s98, 3200000
wb_113:
    ds_read_b128 v[8:11], v2 offset:160
    s_waitcnt lgkmcnt(0)
wbc_115:
    v_min3_u32 v8, v8, v9, v10
    v_min_u32 v8, v8, v11
    s_nop 0
    v_readfirstlane_b32 s57, v8
    s_nop 0
    s_cmp_ge_u32 s57, s58
    s_cbranch_scc1 wbd_114
    s_sub_u32 s98, s98, 1
    s_cmp_lg_u32 s98, 0
    s_cbranch_scc1 wb_113
wbd_114:
a0_110:
    s_nop 7
    s_nop 1
    v_max3_f32 v8, v32, v33, v34
    v_max3_f32 v9, v35, v36, v37
    v_max3_f32 v10, v38, v39, v40
    v_max3_f32 v11, v41, v42, v43
    v_max3_f32 v8, v8, v44, v45
    v_max3_f32 v9, v9, v46, v47
    v_max3_f32 v8, v8, v9, v10
    v_max_f32 v8, v8, v11
    s_mov_b32 s59, 0
    v_cmp_nge_f32 vcc, 0x42000000, v8
    s_cbranch_vccnz raw_111
    v_exp_f32 v32, v32
    ds_read_b64_tr_b16 v[192:193], v28 offset:0
    v_exp_f32 v33, v33
    ds_read_b64_tr_b16 v[194:195], v30 offset:1024
    v_exp_f32 v34, v34
    ds_read_b64_tr_b16 v[196:197], v29 offset:0
    v_exp_f32 v35, v35
    ds_read_b64_tr_b16 v[198:199], v31 offset:1024
    v_exp_f32 v36, v36
    ds_read_b64_tr_b16 v[200:201], v28 offset:2048
    v_exp_f32 v37, v37
    ds_read_b64_tr_b16 v[202:203], v30 offset:3072
    v_exp_f32 v38, v38
    ds_read_b64_tr_b16 v[204:205], v29 offset:2048
    v_exp_f32 v39, v39
    ds_read_b64_tr_b16 v[206:207], v31 offset:3072
    v_exp_f32 v40, v40
    ds_read_b64_tr_b16 v[208:209], v28 offset:4096
    v_exp_f32 v41, v41
    ds_read_b64_tr_b16 v[210:211], v30 offset:5120
    v_exp_f32 v42, v42
    ds_read_b64_tr_b16 v[212:213], v29 offset:4096
    v_exp_f32 v43, v43
    ds_read_b64_tr_b16 v[214:215], v31 offset:5120
    v_exp_f32 v44, v44
    ds_read_b64_tr_b16 v[216:217], v28 offset:6144
    v_exp_f32 v45, v45
    ds_read_b64_tr_b16 v[218:219], v30 offset:7168
    v_exp_f32 v46, v46
    ds_read_b64_tr_b16 v[220:221], v29 offset:6144
    v_exp_f32 v47, v47
    ds_read_b64_tr_b16 v[222:223], v31 offset:7168
    v_cvt_pk_bf16_f32 v48, v32, v33
    v_cvt_pk_bf16_f32 v49, v34, v35
    v_cvt_pk_bf16_f32 v50, v36, v37
    v_cvt_pk_bf16_f32 v51, v38, v39
    ds_write_b128 v26, v[48:51]
    v_cvt_pk_bf16_f32 v52, v40, v41
    v_cvt_pk_bf16_f32 v53, v42, v43
    v_cvt_pk_bf16_f32 v54, v44, v45
    v_cvt_pk_bf16_f32 v55, v46, v47
    ds_write_b128 v26, v[52:55] offset:1024
    s_branch x3_112
raw_111:
    s_mov_b32 s59, 1
    ds_write_b32 v2, v7 offset:208
    ds_read_b64_tr_b16 v[192:193], v28 offset:0
    ds_read_b64_tr_b16 v[194:195], v30 offset:1024
    ds_read_b64_tr_b16 v[196:197], v29 offset:0
    ds_read_b64_tr_b16 v[198:199], v31 offset:1024
    ds_read_b64_tr_b16 v[200:201], v28 offset:2048
    ds_read_b64_tr_b16 v[202:203], v30 offset:3072
    ds_read_b64_tr_b16 v[204:205], v29 offset:2048
    ds_read_b64_tr_b16 v[206:207], v31 offset:3072
    ds_read_b64_tr_b16 v[208:209], v28 offset:4096
    ds_read_b64_tr_b16 v[210:211], v30 offset:5120
    ds_read_b64_tr_b16 v[212:213], v29 offset:4096
    ds_read_b64_tr_b16 v[214:215], v31 offset:5120
    ds_read_b64_tr_b16 v[216:217], v28 offset:6144
    ds_read_b64_tr_b16 v[218:219], v30 offset:7168
    ds_read_b64_tr_b16 v[220:221], v29 offset:6144
    ds_read_b64_tr_b16 v[222:223], v31 offset:7168
x3_112:
    s_waitcnt lgkmcnt(0)
    s_barrier
    s_setprio 0
L_pv2:
    s_cmp_lg_u32 s28, 0
    s_cbranch_scc1 hs_116
    v_mov_b32 v64, s32
    v_mov_b32 v65, s33
    v_mov_b32 v66, s32
    v_mov_b32 v67, s33
    s_lshl_b32 s57, s3, 9
    s_add_u32 s57, s57, 721024
    s_mov_b64 exec, 0xff
    buffer_store_dwordx4 v[64:67], v3, s[36:39], s57 offen sc1
    s_mov_b64 exec, -1
hs_116:
    v_and_b32 v5, 7, v1
    ds_read_b32 v12, v2 offset:208
L_pv2b:
    ds_read_b128 v[48:51], v27 offset:0
    ds_read_b128 v[52:55], v27 offset:1024
    ds_read_b128 v[56:59], v27 offset:2048
    ds_read_b128 v[60:63], v27 offset:3072
    s_waitcnt lgkmcnt(3)
    v_readfirstlane_b32 s101, v12
    s_nop 0
    s_cmp_lg_u32 s101, 0
    s_cbranch_scc1 L_slow
    v_mfma_f32_32x32x16_bf16 v[224:239], v[192:195], v[48:51], v[224:239]
    ds_read_b64_tr_b16 v[192:193], v28 offset:8192
    ds_read_b64_tr_b16 v[194:195], v30 offset:9216
    s_cmp_lt_u32 s28, 4
    s_cbranch_scc1 rs_117
    v_add_f32 v32, v32, v40
    v_add_f32 v33, v33, v41
    v_add_f32 v34, v34, v42
    v_add_f32 v35, v35, v43
    v_add_f32 v36, v36, v44
    v_add_f32 v37, v37, v45
    v_add_f32 v38, v38, v46
    v_add_f32 v39, v39, v47
    v_add_f32 v32, v32, v36
    v_add_f32 v33, v33, v37
    v_add_f32 v34, v34, v38
    v_add_f32 v35, v35, v39
    v_add_f32 v32, v32, v34
    v_add_f32 v33, v33, v35
    v_add_f32 v10, v32, v33
    v_add_f32 v10, v10, v15
    v_mov_b32 v11, v10
    s_nop 1
    v_permlane32_swap_b32 v10, v11
    v_add_f32 v10, v10, v11
    ds_write_b32 v25, v10 offset:768
    ds_write_b32 v6, v7 offset:176
rs_117:
    v_lshlrev_b32 v12, 3, v5
    v_lshrrev_b64 v[12:13], v12, s[24:25]
    s_bitcmp1_b32 s3, 0
    s_cselect_b32 s60, s62, 0
    v_and_b32 v12, 0xff, v12
    v_lshl_or_b32 v12, v12, 15, v12
    v_lshrrev_b32 v16, 0, v12
    v_lshrrev_b32 v17, 2, v12
    v_lshrrev_b32 v18, 4, v12
    v_lshrrev_b32 v19, 6, v12
    v_mfma_f32_32x32x16_bf16 v[240:255], v[196:199], v[48:51], v[240:255]
    ds_read_b64_tr_b16 v[196:197], v29 offset:8192
    ds_read_b64_tr_b16 v[198:199], v31 offset:9216
    ds_read_b128 v[48:51], v27 offset:4096
    s_waitcnt lgkmcnt(7)
    v_mfma_f32_32x32x16_bf16 v[224:239], v[200:203], v[52:55], v[224:239]
    ds_read_b64_tr_b16 v[200:201], v28 offset:10240
    ds_read_b64_tr_b16 v[202:203], v30 offset:11264
    v_and_b32 v4, 31, v1
    v_lshrrev_b32 v13, 5, v1
    v_lshlrev_b32 v13, 2, v13
    v_xor_b32 v13, v13, v5
    v_lshlrev_b32 v4, 7, v4
    s_lshl_b32 s54, s28, 14
    v_add_u32 v4, s54, v4
    v_mfma_f32_32x32x16_bf16 v[240:255], v[204:207], v[52:55], v[240:255]
    ds_read_b64_tr_b16 v[204:205], v29 offset:10240
    ds_read_b64_tr_b16 v[206:207], v31 offset:11264
    ds_read_b128 v[52:55], v27 offset:5120
    s_waitcnt lgkmcnt(11)
    v_mfma_f32_32x32x16_bf16 v[224:239], v[208:211], v[56:59], v[224:239]
    ds_read_b64_tr_b16 v[208:209], v28 offset:12288
    ds_read_b64_tr_b16 v[210:211], v30 offset:13312
    v_xor_b32 v6, 0, v13
    v_lshl_add_u32 v20, v6, 4, v4
    v_xor_b32 v6, 1, v13
    v_lshl_add_u32 v21, v6, 4, v4
    v_xor_b32 v6, 2, v13
    v_lshl_add_u32 v22, v6, 4, v4
    v_xor_b32 v6, 3, v13
    v_lshl_add_u32 v23, v6, 4, v4
    v_mfma_f32_32x32x16_bf16 v[240:255], v[212:215], v[56:59], v[240:255]
    ds_read_b64_tr_b16 v[212:213], v29 offset:12288
    ds_read_b64_tr_b16 v[214:215], v31 offset:13312
    ds_read_b128 v[56:59], v27 offset:6144
    s_waitcnt lgkmcnt(15)
    v_mfma_f32_32x32x16_bf16 v[224:239], v[216:219], v[60:63], v[224:239]
    ds_read_b64_tr_b16 v[216:217], v28 offset:14336
    ds_read_b64_tr_b16 v[218:219], v30 offset:15360
    v_lshrrev_b32 v4, 3, v1
    v_xor_b32 v6, v4, v5
    v_lshlrev_b32 v7, 7, v4
    v_lshl_add_u32 v7, v6, 4, v7
    v_add_u32 v7, s54, v7
    v_mfma_f32_32x32x16_bf16 v[240:255], v[220:223], v[60:63], v[240:255]
    ds_read_b64_tr_b16 v[220:221], v29 offset:14336
    ds_read_b64_tr_b16 v[222:223], v31 offset:15360
    ds_read_b128 v[60:63], v27 offset:7168
    s_waitcnt lgkmcnt(15)
    v_mfma_f32_32x32x16_bf16 v[224:239], v[192:195], v[48:51], v[224:239]
    v_lshlrev_b32 v6, 2, v4
    v_xor_b32 v6, s3, v6
    v_lshlrev_b32 v14, 17, v4
    v_lshl_add_u32 v14, v6, 7, v14
    v_lshl_add_u32 v14, v5, 4, v14
    s_lshl_b32 s55, s28, 7
    s_add_u32 s55, s55, s8
    s_and_b32 s55, s55, 0x380
    s_lshl_b32 s55, s55, 7
    s_add_u32 s55, s55, 4194304
    v_mfma_f32_32x32x16_bf16 v[240:255], v[196:199], v[48:51], v[240:255]
    s_waitcnt lgkmcnt(10)
    v_mfma_f32_32x32x16_bf16 v[224:239], v[200:203], v[52:55], v[224:239]
    v_mfma_f32_32x32x16_bf16 v[240:255], v[204:207], v[52:55], v[240:255]
    s_waitcnt lgkmcnt(5)
    v_mfma_f32_32x32x16_bf16 v[224:239], v[208:211], v[56:59], v[224:239]
    v_mfma_f32_32x32x16_bf16 v[240:255], v[212:215], v[56:59], v[240:255]
    s_waitcnt lgkmcnt(0)
    v_mfma_f32_32x32x16_bf16 v[224:239], v[216:219], v[60:63], v[224:239]
    v_mfma_f32_32x32x16_bf16 v[240:255], v[220:223], v[60:63], v[240:255]
    s_cmp_lg_u32 s28, 3
    s_cbranch_scc1 ls_118
    s_mov_b32 s98, 3200000
wf_119:
    ds_read_b128 v[32:35], v2 offset:176
    s_waitcnt lgkmcnt(0)
    v_and_b32 v32, v32, v33
    v_and_b32 v34, v34, v35
    v_and_b32 v32, v32, v34
    s_nop 0
    v_readfirstlane_b32 s101, v32
    s_nop 0
    s_cmp_lg_u32 s101, 0
    s_cbranch_scc1 wfd_120
    s_sub_u32 s98, s98, 1
    s_cmp_lg_u32 s98, 0
    s_cbranch_scc1 wf_119
wfd_120:
    ds_read_b128 v[32:35], v24 offset:768
    s_lshl_b32 s58, s3, 9
    s_add_u32 s58, s58, 655360
    v_mov_b32 v10, s32
    v_mov_b32 v11, s33
    s_waitcnt lgkmcnt(0)
    v_add_f32 v32, v32, v33
    v_add_f32 v34, v34, v35
    v_add_f32 v9, v32, v34
    s_mov_b32 exec_hi, 0
    buffer_store_dwordx4 v[8:11], v3, s[36:39], s58 offen sc1
    s_mov_b64 exec, -1
ls_118:
    s_nop 7
    s_nop 3
    v_cvt_pk_bf16_f32 v64, v224, v225
    v_cvt_pk_bf16_f32 v65, v226, v227
    v_cvt_pk_bf16_f32 v66, v228, v229
    v_cvt_pk_bf16_f32 v67, v230, v231
    v_cvt_pk_bf16_f32 v68, v232, v233
    v_cvt_pk_bf16_f32 v69, v234, v235
    v_cvt_pk_bf16_f32 v70, v236, v237
    v_cvt_pk_bf16_f32 v71, v238, v239
    ds_write_b128 v20, v[64:67]
    ds_write_b128 v21, v[68:71]
    v_cvt_pk_bf16_f32 v72, v240, v241
    v_cvt_pk_bf16_f32 v73, v242, v243
    v_cvt_pk_bf16_f32 v74, v244, v245
    v_cvt_pk_bf16_f32 v75, v246, v247
    v_cvt_pk_bf16_f32 v76, v248, v249
    v_cvt_pk_bf16_f32 v77, v250, v251
    v_cvt_pk_bf16_f32 v78, v252, v253
    v_cvt_pk_bf16_f32 v79, v254, v255
    ds_write_b128 v22, v[72:75]
    ds_write_b128 v23, v[76:79]
    s_waitcnt lgkmcnt(0)
    ds_read_b128 v[80:83], v7 offset:0
    ds_read_b128 v[84:87], v7 offset:1024
    ds_read_b128 v[88:91], v7 offset:2048
    ds_read_b128 v[92:95], v7 offset:3072
    s_waitcnt lgkmcnt(3)
    v_bfi_b32 v80, s62, v16, v80
    v_bfi_b32 v81, s62, v17, v81
    v_bfi_b32 v82, s62, v18, v82
    v_bfi_b32 v83, s62, v19, v83
    buffer_store_dwordx4 v[80:83], v14, s[36:39], s55 offen sc1
    s_add_u32 s55, s55, 1048576
    s_waitcnt lgkmcnt(2)
    v_bfi_b32 v84, s62, v16, v84
    v_bfi_b32 v85, s62, v17, v85
    v_bfi_b32 v86, s62, v18, v86
    v_bfi_b32 v87, s62, v19, v87
    buffer_store_dwordx4 v[84:87], v14, s[36:39], s55 offen sc1
    s_add_u32 s55, s55, 1048576
    s_waitcnt lgkmcnt(1)
    v_bfi_b32 v88, s62, v16, v88
    v_bfi_b32 v89, s62, v17, v89
    v_bfi_b32 v90, s62, v18, v90
    v_bfi_b32 v91, s62, v19, v91
    buffer_store_dwordx4 v[88:91], v14, s[36:39], s55 offen sc1
    s_add_u32 s55, s55, 1048576
    s_waitcnt lgkmcnt(0)
    v_bfi_b32 v92, s62, v16, v92
    v_bfi_b32 v93, s62, v17, v93
    v_bfi_b32 v94, s62, v18, v94
    v_bfi_b32 v95, s62, v19, v95
    buffer_store_dwordx4 v[92:95], v14, s[36:39], s55 offen sc1
    s_sub_u32 s61, s2, 128
    s_cmp_ge_u32 s61, 32
    s_cbranch_scc1 L_fin
    v_lshrrev_b32 v4, 5, v1
    v_lshl_add_u32 v4, v5, 1, v4
    v_lshl_add_u32 v5, v4, 2, v2
    s_cmp_ge_u32 s28, 4
    s_cbranch_scc1 fa_121
    s_lshl_b32 s52, s61, 13
    s_add_u32 s52, s52, 3145728
    s_cmp_lg_u32 s28, 0
    s_cbranch_scc1 L_fin
    s_mov_b32 s98, 200000
fg_122:
    s_mov_b32 s55, s52
    buffer_load_dwordx4 v[96:99], v3, s[36:39], s55 offen offset:0 sc1
    buffer_load_dwordx4 v[100:103], v3, s[36:39], s55 offen offset:1024 sc1
    buffer_load_dwordx4 v[104:107], v3, s[36:39], s55 offen offset:2048 sc1
    buffer_load_dwordx4 v[108:111], v3, s[36:39], s55 offen offset:3072 sc1
    s_add_u32 s55, s55, 4096
    buffer_load_dwordx4 v[112:115], v3, s[36:39], s55 offen offset:0 sc1
    buffer_load_dwordx4 v[116:119], v3, s[36:39], s55 offen offset:1024 sc1
    s_waitcnt vmcnt(0)
    v_cmp_eq_u64 s[56:57], s[32:33], v[98:99]
    v_cmp_eq_u64 vcc, s[32:33], v[102:103]
    s_nop 0
    s_and_b64 s[56:57], s[56:57], vcc
    v_cmp_eq_u64 vcc, s[32:33], v[106:107]
    s_nop 0
    s_and_b64 s[56:57], s[56:57], vcc
    v_cmp_eq_u64 vcc, s[32:33], v[110:111]
    s_nop 0
    s_and_b64 s[56:57], s[56:57], vcc
    v_cmp_eq_u64 vcc, s[32:33], v[114:115]
    s_nop 0
    s_and_b64 s[56:57], s[56:57], vcc
    v_cmp_eq_u64 vcc, s[32:33], v[118:119]
    s_nop 0
    s_and_b64 s[56:57], s[56:57], vcc
    s_cmp_eq_u64 s[56:57], -1
    s_cbranch_scc1 fgd_123
    s_sub_u32 s98, s98, 1
    s_cmp_lg_u32 s98, 0
    s_cbranch_scc1 fg_122
fgd_123:
    v_add_f32 v96, v96, v108
    v_add_f32 v97, v97, v109
    v_add_f32 v100, v100, v112
    v_add_f32 v101, v101, v113
    v_add_f32 v104, v104, v116
    v_add_f32 v105, v105, v117
    v_add_f32 v96, v96, v104
    v_add_f32 v97, v97, v105
    v_add_f32 v96, v96, v100
    v_add_f32 v97, v97, v101
    s_nop 1
    v_permlane32_swap_b32 v96, v97
    v_add_f32 v96, v96, v97
    v_mov_b32 v97, v96
    s_nop 1
    v_permlane16_swap_b32 v96, v97
    v_add_f32 v96, v96, v97
    s_nop 1
    v_add_f32_dpp v96, v96, v96 row_ror:8 row_mask:0xf bank_mask:0xf
    v_cvt_pk_bf16_f32 v96, v96, v96
    v_and_b32 v96, 0xffff0000, v96
    v_mul_f32 v100, 0xbfb8aa3b, v96
    v_exp_f32 v100, v100
    s_nop 0
    v_add_f32 v100, 1.0, v100
    v_rcp_f32 v100, v100
    s_nop 0
    v_mul_f32 v96, v96, v100
    v_cvt_pk_bf16_f32 v96, v96, v96
    v_and_b32 v96, 0xffff0000, v96
    ds_write_b32 v5, v96 offset:4608
    s_waitcnt lgkmcnt(0)
    s_branch L_fin
fa_121:
    s_mov_b32 s40, s4
    s_mov_b32 s41, s5
    s_mov_b32 s42, 0x400
    s_mov_b32 s43, 0x20000
    s_mov_b32 s44, s22
    s_mov_b32 s45, s23
    s_mov_b32 s46, 0x400
    s_mov_b32 s47, 0x20000
    s_lshl_b32 s52, s61, 14
    s_lshl_b32 s53, s31, 12
    s_add_u32 s52, s52, s53
    s_add_u32 s52, s52, 2097152
    s_lshl_b32 s55, s31, 6
    v_add_u32 v5, s55, v5
    v_and_b32 v6, 15, v1
    v_lshrrev_b32 v60, 1, v6
    v_lshlrev_b32 v60, 4, v60
    v_and_b32 v61, 1, v6
    v_lshl_add_u32 v60, v61, 1, v60
    s_lshl_b32 s54, s34, 7
    s_and_b32 s55, s35, 3
    s_lshl_b32 s55, s55, 2
    s_add_u32 s54, s54, s55
    buffer_load_ushort v62, v60, s[40:43], s54 offen
    v_lshl_add_u32 v6, v6, 2, v2
    v_lshl_add_u32 v7, v1, 2, v2
    s_mov_b32 s98, 200000
fg_125:
    s_mov_b32 s55, s52
    buffer_load_dwordx4 v[96:99], v3, s[36:39], s55 offen offset:0 sc1
    buffer_load_dwordx4 v[100:103], v3, s[36:39], s55 offen offset:1024 sc1
    buffer_load_dwordx4 v[104:107], v3, s[36:39], s55 offen offset:2048 sc1
    buffer_load_dwordx4 v[108:111], v3, s[36:39], s55 offen offset:3072 sc1
    s_waitcnt vmcnt(0)
    v_cmp_eq_u64 s[56:57], s[32:33], v[98:99]
    v_cmp_eq_u64 vcc, s[32:33], v[102:103]
    s_nop 0
    s_and_b64 s[56:57], s[56:57], vcc
    v_cmp_eq_u64 vcc, s[32:33], v[106:107]
    s_nop 0
    s_and_b64 s[56:57], s[56:57], vcc
    v_cmp_eq_u64 vcc, s[32:33], v[110:111]
    s_nop 0
    s_and_b64 s[56:57], s[56:57], vcc
    s_cmp_eq_u64 s[56:57], -1
    s_cbranch_scc1 fgd_126
    s_sub_u32 s98, s98, 1
    s_cmp_lg_u32 s98, 0
    s_cbranch_scc1 fg_125
fgd_126:
    v_add_f32 v96, v96, v104
    v_add_f32 v97, v97, v105
    v_add_f32 v100, v100, v108
    v_add_f32 v101, v101, v109
    v_add_f32 v96, v96, v100
    v_add_f32 v97, v97, v101
    s_nop 1
    v_permlane32_swap_b32 v96, v97
    v_add_f32 v96, v96, v97
    v_mov_b32 v97, v96
    s_nop 1
    v_permlane16_swap_b32 v96, v97
    v_add_f32 v96, v96, v97
    s_nop 1
    v_add_f32_dpp v96, v96, v96 row_ror:8 row_mask:0xf bank_mask:0xf
    ds_write_b32 v5, v96 offset:4096
    s_waitcnt lgkmcnt(0)
    s_barrier
    s_cmp_lg_u32 s28, 4
    s_cbranch_scc1 L_fin
    ds_read_b32 v8, v7 offset:4096
    ds_read_b32 v10, v6 offset:4608
    s_waitcnt lgkmcnt(0)
    v_mov_b32 v9, v8
    s_nop 1
    v_permlane32_swap_b32 v8, v9
    v_add_f32 v8, v8, v9
    v_mov_b32 v9, v8
    s_nop 1
    v_permlane16_swap_b32 v8, v9
    v_add_f32 v8, v8, v9
    v_cvt_pk_bf16_f32 v8, v8, v8
    v_and_b32 v8, 0xffff0000, v8
    v_mul_f32 v8, v8, v10
    v_cvt_pk_bf16_f32 v8, v8, v8
    v_and_b32 v8, 0xffff0000, v8
    v_lshlrev_b32 v62, 16, v62
    v_add_f32 v8, v8, v62
    v_cvt_pk_bf16_f32 v8, v8, v8
    s_mov_b64 exec, 0xffff
    buffer_store_short v8, v60, s[44:47], s54 offen
    s_mov_b64 exec, -1
    s_branch L_fin
L_slow:
    s_waitcnt lgkmcnt(0)
    s_cmp_lt_u32 s28, 4
    s_cbranch_scc1 sb_128
    v_mov_b32 v9, v8
    s_nop 1
    v_permlane32_swap_b32 v8, v9
    v_max_f32 v8, v8, v9
    ds_write_b32 v25, v8 offset:5120
    s_waitcnt lgkmcnt(0)
sb_128:
    s_barrier
    ds_read_b128 v[16:19], v24 offset:5120
    s_waitcnt lgkmcnt(0)
    v_max3_f32 v16, v16, v17, v18
    v_max3_f32 v16, v16, v19, 0
    v_sub_f32 v17, 0, v16
    v_exp_f32 v17, v17
    s_nop 0
    v_mul_f32 v224, v224, v17
    v_mul_f32 v225, v225, v17
    v_mul_f32 v226, v226, v17
    v_mul_f32 v227, v227, v17
    v_mul_f32 v228, v228, v17
    v_mul_f32 v229, v229, v17
    v_mul_f32 v230, v230, v17
    v_mul_f32 v231, v231, v17
    v_mul_f32 v232, v232, v17
    v_mul_f32 v233, v233, v17
    v_mul_f32 v234, v234, v17
    v_mul_f32 v235, v235, v17
    v_mul_f32 v236, v236, v17
    v_mul_f32 v237, v237, v17
    v_mul_f32 v238, v238, v17
    v_mul_f32 v239, v239, v17
    v_mul_f32 v240, v240, v17
    v_mul_f32 v241, v241, v17
    v_mul_f32 v242, v242, v17
    v_mul_f32 v243, v243, v17
    v_mul_f32 v244, v244, v17
    v_mul_f32 v245, v245, v17
    v_mul_f32 v246, v246, v17
    v_mul_f32 v247, v247, v17
    v_mul_f32 v248, v248, v17
    v_mul_f32 v249, v249, v17
    v_mul_f32 v250, v250, v17
    v_mul_f32 v251, v251, v17
    v_mul_f32 v252, v252, v17
    v_mul_f32 v253, v253, v17
    v_mul_f32 v254, v254, v17
    v_mul_f32 v255, v255, v17
    s_cmp_ge_u32 s28, 4
    s_cbranch_scc1 se_131
    v_add_f32 v8, v8, v16
    s_branch sj_130
se_131:
    v_mul_f32 v15, v15, v17
    s_cmp_lg_u32 s59, 0
    s_cbranch_scc1 sr_129
    v_mul_f32 v32, v32, v17
    v_mul_f32 v33, v33, v17
    v_mul_f32 v34, v34, v17
    v_mul_f32 v35, v35, v17
    v_mul_f32 v36, v36, v17
    v_mul_f32 v37, v37, v17
    v_mul_f32 v38, v38, v17
    v_mul_f32 v39, v39, v17
    v_mul_f32 v40, v40, v17
    v_mul_f32 v41, v41, v17
    v_mul_f32 v42, v42, v17
    v_mul_f32 v43, v43, v17
    v_mul_f32 v44, v44, v17
    v_mul_f32 v45, v45, v17
    v_mul_f32 v46, v46, v17
    v_mul_f32 v47, v47, v17
    s_branch sc_132
sr_129:
    v_sub_f32 v32, v32, v16
    v_sub_f32 v33, v33, v16
    v_sub_f32 v34, v34, v16
    v_sub_f32 v35, v35, v16
    v_sub_f32 v36, v36, v16
    v_sub_f32 v37, v37, v16
    v_sub_f32 v38, v38, v16
    v_sub_f32 v39, v39, v16
    v_sub_f32 v40, v40, v16
    v_sub_f32 v41, v41, v16
    v_sub_f32 v42, v42, v16
    v_sub_f32 v43, v43, v16
    v_sub_f32 v44, v44, v16
    v_sub_f32 v45, v45, v16
    v_sub_f32 v46, v46, v16
    v_sub_f32 v47, v47, v16
    v_exp_f32 v32, v32
    v_exp_f32 v33, v33
    v_exp_f32 v34, v34
    v_exp_f32 v35, v35
    v_exp_f32 v36, v36
    v_exp_f32 v37, v37
    v_exp_f32 v38, v38
    v_exp_f32 v39, v39
    v_exp_f32 v40, v40
    v_exp_f32 v41, v41
    v_exp_f32 v42, v42
    v_exp_f32 v43, v43
    v_exp_f32 v44, v44
    v_exp_f32 v45, v45
    v_exp_f32 v46, v46
    v_exp_f32 v47, v47
sc_132:
    s_nop 1
    v_cvt_pk_bf16_f32 v48, v32, v33
    v_cvt_pk_bf16_f32 v49, v34, v35
    v_cvt_pk_bf16_f32 v50, v36, v37
    v_cvt_pk_bf16_f32 v51, v38, v39
    v_cvt_pk_bf16_f32 v52, v40, v41
    v_cvt_pk_bf16_f32 v53, v42, v43
    v_cvt_pk_bf16_f32 v54, v44, v45
    v_cvt_pk_bf16_f32 v55, v46, v47
    ds_write_b128 v26, v[48:51]
    ds_write_b128 v26, v[52:55] offset:1024
sj_130:
    v_mov_b32 v12, 0
    s_waitcnt lgkmcnt(0)
    s_barrier
    s_branch L_pv2b
L_fin:
L_end:
    s_endpgm
L_codeend:
.fill 272, 4, 0xBF810000
.section .rodata,"a"
.p2align 6
.amdhsa_kernel recurrent_scan__compressed_kv_cla__dense_activation_silu__decode_kernel
  .amdhsa_next_free_vgpr 256
  .amdhsa_next_free_sgpr 102
  .amdhsa_accum_offset 256
  .amdhsa_group_segment_fixed_size 0
  .amdhsa_kernarg_size 96
  .amdhsa_user_sgpr_count 2
  .amdhsa_user_sgpr_kernarg_segment_ptr 1
  .amdhsa_system_sgpr_workgroup_id_x 1
  .amdhsa_float_denorm_mode_32 3
.end_amdhsa_kernel
```
